```python
import torch

def _softmax(x, axis=-1):
    return torch.softmax(x, dim=axis)
def _gelu(x):
    return torch.nn.functional.gelu(x, approximate="tanh")
def _silu(x):
    return torch.nn.functional.silu(x)
def _sigmoid(x):
    return torch.sigmoid(x)
def _layernorm(x, axis=-1, eps=1e-5):
    m = x.mean(dim=axis, keepdim=True)
    v = x.var(dim=axis, keepdim=True, unbiased=False)
    return (x - m) / torch.sqrt(v + eps)
def _scatter_add(tgt, idx, src, axis=0):
    return tgt.clone().index_add_(axis, idx, src)
def _segment_sum(src, seg, n):
    out = torch.zeros((n,) + src.shape[1:], dtype=src.dtype)
    return out.index_add_(0, seg, src)
def _pad(x, pw):
    flat = tuple(v for pair in reversed(pw) for v in pair)
    return torch.nn.functional.pad(x, flat)

kernel_name = 'standalone__gqa_softmax__near_ridge'

def setup_inputs():

    _w = (lambda a: (lambda t: t.to(torch.bfloat16) if t.is_floating_point() else t)(torch.as_tensor(a)))
    B, Hq, Hkv, Sq, Sk, D = 16, 16, 8, 192, 512, 256
    return {
        "q": _w((lambda *s: torch.randn(*s, dtype=torch.bfloat16) * 0.8)(B, Hq, Sq, D)),
        "k": _w((lambda *s: torch.randn(*s, dtype=torch.bfloat16) * 0.8)(B, Hkv, Sk, D)),
        "v": _w((lambda *s: torch.randn(*s, dtype=torch.bfloat16) * 0.05)(B, Hkv, Sk, D)),
    }

def reference(q, k, v):
    B, Hq, Sq, D = q.shape
    Hkv = k.shape[1]
    rep = Hq // Hkv
    k = (lambda x, n, axis: torch.repeat_interleave(x, n, dim=axis))(k, rep, axis=1)
    v = (lambda x, n, axis: torch.repeat_interleave(x, n, dim=axis))(v, rep, axis=1)
    scale = D ** -0.5
    scores = torch.einsum("bhqd,bhkd->bhqk", q, k) * scale
    p = _softmax(scores, axis=-1)
    return torch.einsum("bhqk,bhkd->bhqd", p, v)
```

```asm
; @launch grid=(256,1,1) block=(256,1,1) lds=161344
.amdgcn_target "amdgcn-amd-amdhsa--gfx950"
.text
.globl standalone__gqa_softmax__near_ridge_kernel
.p2align 8
.type standalone__gqa_softmax__near_ridge_kernel,@function
standalone__gqa_softmax__near_ridge_kernel:
    s_cmp_ge_u32 s2, 256
    s_cbranch_scc1 L_end
    s_load_dwordx4 s[4:7], s[0:1], 0
    s_load_dwordx4 s[24:27], s[0:1], 16
    s_getpc_b64 s[44:45]
L_pc:
    s_sub_u32 s40, s44, L_pc-standalone__gqa_softmax__near_ridge_kernel
    s_subb_u32 s41, s45, 0
    s_mov_b32 s42, L_code_end-standalone__gqa_softmax__near_ridge_kernel
    s_mov_b32 s43, 0x00020000
    s_bfe_u32 s51, s2, 0x50003
    s_cmp_ge_u32 s51, 17
    s_cselect_b32 s52, 17, 0
    s_sub_u32 s51, s51, s52
    s_lshl_b32 s51, s51, 11
    v_lshlrev_b32 v25, 3, v0
    buffer_load_dwordx2 v[192:193], v25, s[40:43], s51 offen
    v_lshrrev_b32 v19, 6, v0
    v_and_b32 v20, 63, v0
    s_and_b32 s46, s2, 7
    s_lshr_b32 s47, s2, 3
    v_readfirstlane_b32 s3, v19
    s_and_b32 s48, s47, 1
    s_lshr_b32 s47, s47, 1
    s_lshl_b32 s46, s46, 4
    s_add_u32 s46, s46, s47
    s_lshl_b32 s47, s46, 1
    s_add_u32 s47, s47, s48
    s_mul_i32 s47, s47, 98304
    s_lshl_b32 s46, s46, 18
    v_and_b32 v21, 15, v20
    v_lshrrev_b32 v23, 4, v20
    s_mul_i32 s50, s3, 24576
    v_lshrrev_b32 v22, 3, v20
    v_bfe_u32 v24, v20, 4, 1
    v_lshlrev_b32 v24, 2, v24
    v_and_b32 v26, 7, v20
    v_xor_b32 v26, v26, v24
    v_lshlrev_b32 v26, 4, v26
    v_lshl_add_u32 v24, v22, 9, v26
    s_mul_i32 s53, s3, 8448
    s_add_u32 s53, s53, 50688
    s_mov_b32 s10, 98304
    v_add_u32 v1, s50, v24
    s_mov_b32 s11, 0x00020000
    s_mov_b32 s31, 8192
    s_mov_b32 s32, 16384
    v_lshrrev_b32 v22, 5, v20
    v_and_b32 v24, 31, v20
    v_xor_b32 v24, v24, v22
    v_lshlrev_b32 v24, 4, v24
    v_lshl_add_u32 v24, v22, 9, v24
    s_lshl_b32 s49, s3, 12
    s_add_u32 s49, s49, 96
    v_add_u32 v5, s49, v24
    v_subrev_u32 v6, 32, v5
    v_subrev_u32 v7, 64, v5
    v_add_u32 v8, 0xffffffa0, v5
    s_mul_i32 s28, s3, 4224
    s_waitcnt lgkmcnt(0)
    s_add_u32 s12, s6, s46
    s_addc_u32 s13, s7, 0
    s_sub_u32 s12, s12, 96
    s_subb_u32 s13, s13, 0
    s_mov_b32 s14, 262240
    s_mov_b32 s15, 0x00020000
    s_add_u32 m0, s28, 0
    s_mov_b32 s30, 0
    buffer_load_dwordx4 v5, s[12:15], s30 offen offset:0 nt lds
    buffer_load_dwordx4 v6, s[12:15], s30 offen offset:1056 nt lds
    buffer_load_dwordx4 v7, s[12:15], s30 offen offset:2112 nt lds
    buffer_load_dwordx4 v8, s[12:15], s30 offen offset:3168 nt lds
    s_add_u32 s8, s4, s47
    s_addc_u32 s9, s5, 0
    s_add_u32 m0, s53, 0
    s_mov_b32 s30, 0
    buffer_load_dwordx4 v1, s[8:11], s30 offen offset:0 nt lds
    s_add_u32 m0, s53, 1056
    s_mov_b32 s30, 4096
    buffer_load_dwordx4 v1, s[8:11], s30 offen offset:0 nt lds
    s_add_u32 m0, s53, 1984
    s_mov_b32 s30, 0
    buffer_load_dwordx4 v1, s[8:11], s30 offen offset:128 nt lds
    s_add_u32 m0, s53, 3040
    s_mov_b32 s30, 4096
    buffer_load_dwordx4 v1, s[8:11], s30 offen offset:128 nt lds
    s_add_u32 m0, s53, 3968
    s_mov_b32 s30, 0
    buffer_load_dwordx4 v1, s[8:11], s30 offen offset:256 nt lds
    s_add_u32 m0, s53, 5024
    s_mov_b32 s30, 4096
    buffer_load_dwordx4 v1, s[8:11], s30 offen offset:256 nt lds
    s_add_u32 m0, s53, 5952
    s_mov_b32 s30, 0
    buffer_load_dwordx4 v1, s[8:11], s30 offen offset:384 nt lds
    s_add_u32 m0, s53, 7008
    s_mov_b32 s30, 4096
    buffer_load_dwordx4 v1, s[8:11], s30 offen offset:384 nt lds
    s_add_u32 m0, s53, 33792
    s_mov_b32 s30, 8192
    buffer_load_dwordx4 v1, s[8:11], s30 offen offset:0 nt lds
    s_add_u32 m0, s53, 34848
    s_mov_b32 s30, 12288
    buffer_load_dwordx4 v1, s[8:11], s30 offen offset:0 nt lds
    s_add_u32 m0, s53, 35776
    s_mov_b32 s30, 8192
    buffer_load_dwordx4 v1, s[8:11], s30 offen offset:128 nt lds
    s_add_u32 m0, s53, 36832
    s_mov_b32 s30, 12288
    buffer_load_dwordx4 v1, s[8:11], s30 offen offset:128 nt lds
    s_mul_i32 s29, s3, 4128
    s_add_u32 s16, s24, s46
    s_addc_u32 s17, s25, 0
    s_mov_b32 s18, 262144
    s_mov_b32 s19, 0x00020000
    s_add_u32 s20, s26, s47
    s_addc_u32 s21, s27, 0
    s_mov_b32 s22, 98304
    s_mov_b32 s23, 0x00020000
    v_bfe_u32 v22, v21, 2, 1
    v_lshlrev_b32 v22, 3, v22
    v_lshrrev_b32 v24, 3, v21
    v_lshl_or_b32 v22, v24, 2, v22
    v_and_b32 v24, 3, v21
    v_or_b32 v22, v22, v24
    v_and_b32 v24, 1, v22
    v_lshrrev_b32 v22, 1, v22
    v_mul_u32_u24 v22, 1056, v22
    v_lshl_add_u32 v22, v24, 9, v22
    v_xor_b32 v24, v23, v24
    v_lshl_add_u32 v2, v24, 4, v22
    v_add_u32 v3, 50688, v2
    v_add_u32 v4, 101376, v2
    v_lshrrev_b32 v22, 3, v20
    v_bfe_u32 v24, v22, 1, 1
    v_lshlrev_b32 v24, 2, v24
    v_and_b32 v21, 7, v20
    v_xor_b32 v21, v21, v24
    v_lshlrev_b32 v21, 4, v21
    v_lshl_add_u32 v21, v22, 9, v21
    s_lshl_b32 s49, s3, 14
    v_add_u32 v9, s49, v21
    v_add_u32 v10, 3064, v9
    v_add_u32 v11, 6128, v9
    v_add_u32 v12, 9192, v9
    v_bfe_u32 v21, v20, 2, 2
    v_lshrrev_b32 v22, 1, v23
    v_lshl_add_u32 v22, v22, 2, v21
    v_lshlrev_b32 v22, 7, v22
    v_and_b32 v24, 1, v23
    v_mul_u32_u24 v24, 1032, v24
    v_add_u32 v22, v22, v24
    v_and_b32 v24, 3, v20
    v_lshl_add_u32 v22, v24, 4, v22
    v_bfe_u32 v21, v21, 1, 1
    v_lshl_add_u32 v13, v21, 6, v22
    v_xor_b32 v21, 1, v21
    v_lshl_add_u32 v16, v21, 6, v22
    v_add_u32 v14, 50688, v13
    v_add_u32 v15, 101376, v13
    v_add_u32 v17, 50688, v16
    v_add_u32 v18, 101376, v16
    v_and_b32 v21, 15, v20
    v_mul_u32_u24 v21, 144, v21
    v_lshl_add_u32 v21, v23, 4, v21
    s_mul_i32 s49, s3, 2304
    s_add_u32 s49, s49, 152128
    v_lshrrev_b32 v24, 3, v20
    v_and_b32 v25, 7, v20
    v_add_u32 v22, s49, v21
    v_mul_u32_u24 v21, 144, v24
    v_lshl_add_u32 v21, v25, 4, v21
    v_add_u32 v23, s49, v21
    v_lshlrev_b32 v24, 9, v24
    v_lshl_add_u32 v24, v25, 4, v24
    s_mul_i32 s49, s3, 24576
    v_add_u32 v0, s49, v24
    v_and_b32 v21, 15, v20
    v_lshrrev_b32 v24, 3, v21
    v_mul_u32_u24 v24, 1056, v24
    v_and_b32 v25, 7, v21
    v_lshl_add_u32 v24, v25, 7, v24
    v_bfe_u32 v25, v21, 1, 1
    v_lshlrev_b32 v25, 2, v25
    v_lshrrev_b32 v21, 4, v20
    v_xor_b32 v26, v21, v25
    v_lshl_add_u32 v26, v26, 4, v24
    v_or_b32 v21, 4, v21
    v_xor_b32 v27, v21, v25
    v_lshl_add_u32 v27, v27, 4, v24
    v_add_u32 v26, s53, v26
    v_add_u32 v27, s53, v27
    s_mov_b32 s54, 0
    s_mov_b32 s55, 4096
    s_mov_b32 s56, 8192
    s_mov_b32 s57, 12288
    s_mov_b32 s58, 16384
    s_mov_b32 s59, 20480
    s_mov_b32 s34, 0x3db8aa3b
    s_mov_b32 s35, 0x3db8aa3b
    s_mov_b32 s33, 0x47800000
    s_mov_b32 s36, 0
    s_mov_b32 s37, 0xffff0000
    s_lshl_b32 s50, s3, 2
    s_add_u32 s50, s50, 152064
    s_mov_b32 s52, 0x3f803f80
    v_accvgpr_write_b32 a140, s52
    v_accvgpr_write_b32 a141, s52
    v_accvgpr_write_b32 a142, s52
    v_accvgpr_write_b32 a143, s52
    s_waitcnt vmcnt(10)
    ds_read_b128 v[64:67], v26 offset:0
    ds_read_b128 v[68:71], v27 offset:0
    s_add_u32 m0, s53, 37760
    s_mov_b32 s30, 8192
    buffer_load_dwordx4 v1, s[8:11], s30 offen offset:256 nt lds
    s_add_u32 m0, s53, 38816
    s_mov_b32 s30, 12288
    buffer_load_dwordx4 v1, s[8:11], s30 offen offset:256 nt lds
    s_waitcnt lgkmcnt(1)
    v_lshlrev_b32 v160, 16, v64
    v_and_b32 v161, s37, v64
    v_lshlrev_b32 v162, 16, v65
    v_and_b32 v163, s37, v65
    v_lshlrev_b32 v164, 16, v66
    v_and_b32 v165, s37, v66
    v_lshlrev_b32 v166, 16, v67
    v_and_b32 v167, s37, v67
    v_pk_mul_f32 v[160:161], v[160:161], s[34:35]
    v_pk_mul_f32 v[162:163], v[162:163], s[34:35]
    v_pk_mul_f32 v[164:165], v[164:165], s[34:35]
    v_pk_mul_f32 v[166:167], v[166:167], s[34:35]
    v_cvt_pk_bf16_f32 v168, v160, v161
    v_cvt_pk_bf16_f32 v169, v162, v163
    v_cvt_pk_bf16_f32 v170, v164, v165
    v_cvt_pk_bf16_f32 v171, v166, v167
    v_accvgpr_write_b32 a0, v168
    v_accvgpr_write_b32 a1, v169
    v_accvgpr_write_b32 a2, v170
    v_accvgpr_write_b32 a3, v171
    s_waitcnt lgkmcnt(0)
    v_lshlrev_b32 v176, 16, v68
    v_and_b32 v177, s37, v68
    v_lshlrev_b32 v178, 16, v69
    v_and_b32 v179, s37, v69
    v_lshlrev_b32 v180, 16, v70
    v_and_b32 v181, s37, v70
    v_lshlrev_b32 v182, 16, v71
    v_and_b32 v183, s37, v71
    v_pk_mul_f32 v[176:177], v[176:177], s[34:35]
    v_pk_mul_f32 v[178:179], v[178:179], s[34:35]
    v_pk_mul_f32 v[180:181], v[180:181], s[34:35]
    v_pk_mul_f32 v[182:183], v[182:183], s[34:35]
    v_cvt_pk_bf16_f32 v184, v176, v177
    v_cvt_pk_bf16_f32 v185, v178, v179
    v_cvt_pk_bf16_f32 v186, v180, v181
    v_cvt_pk_bf16_f32 v187, v182, v183
    v_accvgpr_write_b32 a4, v184
    v_accvgpr_write_b32 a5, v185
    v_accvgpr_write_b32 a6, v186
    v_accvgpr_write_b32 a7, v187
    s_waitcnt vmcnt(10)
    ds_read_b128 v[72:75], v26 offset:2112
    ds_read_b128 v[76:79], v27 offset:2112
    s_add_u32 m0, s53, 39744
    s_mov_b32 s30, 8192
    buffer_load_dwordx4 v1, s[8:11], s30 offen offset:384 nt lds
    s_add_u32 m0, s53, 40800
    s_mov_b32 s30, 12288
    buffer_load_dwordx4 v1, s[8:11], s30 offen offset:384 nt lds
    s_waitcnt lgkmcnt(1)
    v_lshlrev_b32 v160, 16, v72
    v_and_b32 v161, s37, v72
    v_lshlrev_b32 v162, 16, v73
    v_and_b32 v163, s37, v73
    v_lshlrev_b32 v164, 16, v74
    v_and_b32 v165, s37, v74
    v_lshlrev_b32 v166, 16, v75
    v_and_b32 v167, s37, v75
    v_pk_mul_f32 v[160:161], v[160:161], s[34:35]
    v_pk_mul_f32 v[162:163], v[162:163], s[34:35]
    v_pk_mul_f32 v[164:165], v[164:165], s[34:35]
    v_pk_mul_f32 v[166:167], v[166:167], s[34:35]
    v_cvt_pk_bf16_f32 v168, v160, v161
    v_cvt_pk_bf16_f32 v169, v162, v163
    v_cvt_pk_bf16_f32 v170, v164, v165
    v_cvt_pk_bf16_f32 v171, v166, v167
    v_accvgpr_write_b32 a8, v168
    v_accvgpr_write_b32 a9, v169
    v_accvgpr_write_b32 a10, v170
    v_accvgpr_write_b32 a11, v171
    s_waitcnt lgkmcnt(0)
    v_lshlrev_b32 v176, 16, v76
    v_and_b32 v177, s37, v76
    v_lshlrev_b32 v178, 16, v77
    v_and_b32 v179, s37, v77
    v_lshlrev_b32 v180, 16, v78
    v_and_b32 v181, s37, v78
    v_lshlrev_b32 v182, 16, v79
    v_and_b32 v183, s37, v79
    v_pk_mul_f32 v[176:177], v[176:177], s[34:35]
    v_pk_mul_f32 v[178:179], v[178:179], s[34:35]
    v_pk_mul_f32 v[180:181], v[180:181], s[34:35]
    v_pk_mul_f32 v[182:183], v[182:183], s[34:35]
    v_cvt_pk_bf16_f32 v184, v176, v177
    v_cvt_pk_bf16_f32 v185, v178, v179
    v_cvt_pk_bf16_f32 v186, v180, v181
    v_cvt_pk_bf16_f32 v187, v182, v183
    v_accvgpr_write_b32 a12, v184
    v_accvgpr_write_b32 a13, v185
    v_accvgpr_write_b32 a14, v186
    v_accvgpr_write_b32 a15, v187
    s_waitcnt vmcnt(16)
    s_barrier
    ds_read_b128 a[144:147], v2 offset:0
    ds_read_b128 a[148:151], v2 offset:64
    ds_read_b128 a[152:155], v2 offset:128
    ds_read_b128 a[156:159], v2 offset:192
    ds_read_b128 a[160:163], v2 offset:256
    ds_read_b128 a[164:167], v2 offset:320
    ds_read_b128 a[168:171], v2 offset:384
    ds_read_b128 a[172:175], v2 offset:448
    ds_read_b128 a[176:179], v2 offset:8448
    ds_read_b128 a[180:183], v2 offset:8512
    ds_read_b128 a[184:187], v2 offset:8576
    ds_read_b128 a[188:191], v2 offset:8640
    ds_read_b128 a[192:195], v2 offset:8704
    ds_read_b128 a[196:199], v2 offset:8768
    s_waitcnt vmcnt(10)
    ds_read_b128 v[64:67], v26 offset:4224
    ds_read_b128 v[68:71], v27 offset:4224
    s_add_u32 m0, s53, 67584
    s_mov_b32 s30, 16384
    buffer_load_dwordx4 v1, s[8:11], s30 offen offset:0 nt lds
    s_add_u32 m0, s53, 68640
    s_mov_b32 s30, 20480
    buffer_load_dwordx4 v1, s[8:11], s30 offen offset:0 nt lds
    s_waitcnt lgkmcnt(1)
    v_lshlrev_b32 v160, 16, v64
    v_and_b32 v161, s37, v64
    v_lshlrev_b32 v162, 16, v65
    v_and_b32 v163, s37, v65
    v_lshlrev_b32 v164, 16, v66
    v_and_b32 v165, s37, v66
    v_lshlrev_b32 v166, 16, v67
    v_and_b32 v167, s37, v67
    v_pk_mul_f32 v[160:161], v[160:161], s[34:35]
    v_pk_mul_f32 v[162:163], v[162:163], s[34:35]
    v_pk_mul_f32 v[164:165], v[164:165], s[34:35]
    v_pk_mul_f32 v[166:167], v[166:167], s[34:35]
    v_cvt_pk_bf16_f32 v168, v160, v161
    v_cvt_pk_bf16_f32 v169, v162, v163
    v_cvt_pk_bf16_f32 v170, v164, v165
    v_cvt_pk_bf16_f32 v171, v166, v167
    v_accvgpr_write_b32 a16, v168
    v_accvgpr_write_b32 a17, v169
    v_accvgpr_write_b32 a18, v170
    v_accvgpr_write_b32 a19, v171
    s_waitcnt lgkmcnt(0)
    v_lshlrev_b32 v176, 16, v68
    v_and_b32 v177, s37, v68
    v_lshlrev_b32 v178, 16, v69
    v_and_b32 v179, s37, v69
    v_lshlrev_b32 v180, 16, v70
    v_and_b32 v181, s37, v70
    v_lshlrev_b32 v182, 16, v71
    v_and_b32 v183, s37, v71
    v_pk_mul_f32 v[176:177], v[176:177], s[34:35]
    v_pk_mul_f32 v[178:179], v[178:179], s[34:35]
    v_pk_mul_f32 v[180:181], v[180:181], s[34:35]
    v_pk_mul_f32 v[182:183], v[182:183], s[34:35]
    v_cvt_pk_bf16_f32 v184, v176, v177
    v_cvt_pk_bf16_f32 v185, v178, v179
    v_cvt_pk_bf16_f32 v186, v180, v181
    v_cvt_pk_bf16_f32 v187, v182, v183
    v_accvgpr_write_b32 a20, v184
    v_accvgpr_write_b32 a21, v185
    v_accvgpr_write_b32 a22, v186
    v_accvgpr_write_b32 a23, v187
    s_waitcnt lgkmcnt(15)
    v_mfma_f32_16x16x32_bf16 v[40:43], a[144:147], a[0:3], 0
    s_waitcnt lgkmcnt(14)
    v_mfma_f32_16x16x32_bf16 v[40:43], a[148:151], a[4:7], v[40:43]
    s_waitcnt vmcnt(10)
    ds_read_b128 v[72:75], v26 offset:6336
    ds_read_b128 v[76:79], v27 offset:6336
    v_add_u32 v26, 33792, v26
    v_add_u32 v27, 33792, v27
    s_add_u32 m0, s53, 69568
    s_mov_b32 s30, 16384
    buffer_load_dwordx4 v1, s[8:11], s30 offen offset:128 nt lds
    s_add_u32 m0, s53, 70624
    s_mov_b32 s30, 20480
    buffer_load_dwordx4 v1, s[8:11], s30 offen offset:128 nt lds
    s_waitcnt lgkmcnt(1)
    v_lshlrev_b32 v160, 16, v72
    v_and_b32 v161, s37, v72
    v_lshlrev_b32 v162, 16, v73
    v_and_b32 v163, s37, v73
    v_lshlrev_b32 v164, 16, v74
    v_and_b32 v165, s37, v74
    v_lshlrev_b32 v166, 16, v75
    v_and_b32 v167, s37, v75
    v_pk_mul_f32 v[160:161], v[160:161], s[34:35]
    v_pk_mul_f32 v[162:163], v[162:163], s[34:35]
    v_pk_mul_f32 v[164:165], v[164:165], s[34:35]
    v_pk_mul_f32 v[166:167], v[166:167], s[34:35]
    v_cvt_pk_bf16_f32 v168, v160, v161
    v_cvt_pk_bf16_f32 v169, v162, v163
    v_cvt_pk_bf16_f32 v170, v164, v165
    v_cvt_pk_bf16_f32 v171, v166, v167
    v_accvgpr_write_b32 a24, v168
    v_accvgpr_write_b32 a25, v169
    v_accvgpr_write_b32 a26, v170
    v_accvgpr_write_b32 a27, v171
    s_waitcnt lgkmcnt(15)
    v_mfma_f32_16x16x32_bf16 v[40:43], a[152:155], a[8:11], v[40:43]
    s_waitcnt lgkmcnt(14)
    v_mfma_f32_16x16x32_bf16 v[40:43], a[156:159], a[12:15], v[40:43]
    s_waitcnt lgkmcnt(0)
    v_lshlrev_b32 v176, 16, v76
    v_and_b32 v177, s37, v76
    v_lshlrev_b32 v178, 16, v77
    v_and_b32 v179, s37, v77
    v_lshlrev_b32 v180, 16, v78
    v_and_b32 v181, s37, v78
    v_lshlrev_b32 v182, 16, v79
    v_and_b32 v183, s37, v79
    v_pk_mul_f32 v[176:177], v[176:177], s[34:35]
    v_pk_mul_f32 v[178:179], v[178:179], s[34:35]
    v_pk_mul_f32 v[180:181], v[180:181], s[34:35]
    v_pk_mul_f32 v[182:183], v[182:183], s[34:35]
    v_cvt_pk_bf16_f32 v184, v176, v177
    v_cvt_pk_bf16_f32 v185, v178, v179
    v_cvt_pk_bf16_f32 v186, v180, v181
    v_cvt_pk_bf16_f32 v187, v182, v183
    v_accvgpr_write_b32 a28, v184
    v_accvgpr_write_b32 a29, v185
    v_accvgpr_write_b32 a30, v186
    v_accvgpr_write_b32 a31, v187
    s_waitcnt lgkmcnt(13)
    v_mfma_f32_16x16x32_bf16 v[40:43], a[160:163], a[16:19], v[40:43]
    s_waitcnt lgkmcnt(12)
    v_mfma_f32_16x16x32_bf16 v[40:43], a[164:167], a[20:23], v[40:43]
    s_waitcnt vmcnt(10)
    ds_read_b128 v[64:67], v26 offset:0
    ds_read_b128 v[68:71], v27 offset:0
    s_add_u32 m0, s53, 71552
    s_mov_b32 s30, 16384
    buffer_load_dwordx4 v1, s[8:11], s30 offen offset:256 nt lds
    s_add_u32 m0, s53, 72608
    s_mov_b32 s30, 20480
    buffer_load_dwordx4 v1, s[8:11], s30 offen offset:256 nt lds
    s_waitcnt lgkmcnt(1)
    v_lshlrev_b32 v160, 16, v64
    v_and_b32 v161, s37, v64
    v_lshlrev_b32 v162, 16, v65
    v_and_b32 v163, s37, v65
    v_lshlrev_b32 v164, 16, v66
    v_and_b32 v165, s37, v66
    v_lshlrev_b32 v166, 16, v67
    v_and_b32 v167, s37, v67
    v_pk_mul_f32 v[160:161], v[160:161], s[34:35]
    v_pk_mul_f32 v[162:163], v[162:163], s[34:35]
    v_pk_mul_f32 v[164:165], v[164:165], s[34:35]
    v_pk_mul_f32 v[166:167], v[166:167], s[34:35]
    v_cvt_pk_bf16_f32 v168, v160, v161
    v_cvt_pk_bf16_f32 v169, v162, v163
    v_cvt_pk_bf16_f32 v170, v164, v165
    v_cvt_pk_bf16_f32 v171, v166, v167
    v_accvgpr_write_b32 a32, v168
    v_accvgpr_write_b32 a33, v169
    v_accvgpr_write_b32 a34, v170
    v_accvgpr_write_b32 a35, v171
    s_waitcnt lgkmcnt(13)
    v_mfma_f32_16x16x32_bf16 v[40:43], a[168:171], a[24:27], v[40:43]
    s_waitcnt lgkmcnt(12)
    v_mfma_f32_16x16x32_bf16 v[40:43], a[172:175], a[28:31], v[40:43]
    s_waitcnt lgkmcnt(0)
    v_lshlrev_b32 v176, 16, v68
    v_and_b32 v177, s37, v68
    v_lshlrev_b32 v178, 16, v69
    v_and_b32 v179, s37, v69
    v_lshlrev_b32 v180, 16, v70
    v_and_b32 v181, s37, v70
    v_lshlrev_b32 v182, 16, v71
    v_and_b32 v183, s37, v71
    v_pk_mul_f32 v[176:177], v[176:177], s[34:35]
    v_pk_mul_f32 v[178:179], v[178:179], s[34:35]
    v_pk_mul_f32 v[180:181], v[180:181], s[34:35]
    v_pk_mul_f32 v[182:183], v[182:183], s[34:35]
    v_cvt_pk_bf16_f32 v184, v176, v177
    v_cvt_pk_bf16_f32 v185, v178, v179
    v_cvt_pk_bf16_f32 v186, v180, v181
    v_cvt_pk_bf16_f32 v187, v182, v183
    v_accvgpr_write_b32 a36, v184
    v_accvgpr_write_b32 a37, v185
    v_accvgpr_write_b32 a38, v186
    v_accvgpr_write_b32 a39, v187
    v_mfma_f32_16x16x32_bf16 v[44:47], a[144:147], a[32:35], 0
    v_max3_f32 v24, v40, v41, v42
    v_max_f32 v24, v24, v43
    v_mov_b32 v25, v24
    s_nop 1
    v_permlane32_swap_b32 v24, v25
    s_nop 1
    v_max_f32 v24, v24, v25
    v_mov_b32 v25, v24
    s_nop 1
    v_permlane16_swap_b32 v24, v25
    s_nop 1
    v_max_f32 v24, v24, v25
    v_sub_f32 v28, 0, v24
    v_sub_f32 v29, 0, v24
    v_sub_f32 v30, 0, v24
    v_sub_f32 v31, 0, v24
    v_add_f32 v40, v28, v40
    v_add_f32 v41, v29, v41
    v_add_f32 v42, v30, v42
    v_add_f32 v43, v31, v43
    s_waitcnt vmcnt(10)
    ds_read_b128 v[72:75], v26 offset:2112
    ds_read_b128 v[76:79], v27 offset:2112
    s_add_u32 m0, s53, 73536
    s_mov_b32 s30, 16384
    buffer_load_dwordx4 v1, s[8:11], s30 offen offset:384 nt lds
    s_add_u32 m0, s53, 74592
    s_mov_b32 s30, 20480
    buffer_load_dwordx4 v1, s[8:11], s30 offen offset:384 nt lds
    s_waitcnt lgkmcnt(1)
    v_lshlrev_b32 v160, 16, v72
    v_and_b32 v161, s37, v72
    v_lshlrev_b32 v162, 16, v73
    v_and_b32 v163, s37, v73
    v_lshlrev_b32 v164, 16, v74
    v_and_b32 v165, s37, v74
    v_lshlrev_b32 v166, 16, v75
    v_and_b32 v167, s37, v75
    v_pk_mul_f32 v[160:161], v[160:161], s[34:35]
    v_pk_mul_f32 v[162:163], v[162:163], s[34:35]
    v_pk_mul_f32 v[164:165], v[164:165], s[34:35]
    v_pk_mul_f32 v[166:167], v[166:167], s[34:35]
    v_cvt_pk_bf16_f32 v168, v160, v161
    v_cvt_pk_bf16_f32 v169, v162, v163
    v_cvt_pk_bf16_f32 v170, v164, v165
    v_cvt_pk_bf16_f32 v171, v166, v167
    v_accvgpr_write_b32 a40, v168
    v_accvgpr_write_b32 a41, v169
    v_accvgpr_write_b32 a42, v170
    v_accvgpr_write_b32 a43, v171
    v_mfma_f32_16x16x32_bf16 v[44:47], a[148:151], a[36:39], v[44:47]
    s_waitcnt lgkmcnt(0)
    v_lshlrev_b32 v176, 16, v76
    v_and_b32 v177, s37, v76
    v_lshlrev_b32 v178, 16, v77
    v_and_b32 v179, s37, v77
    v_lshlrev_b32 v180, 16, v78
    v_and_b32 v181, s37, v78
    v_lshlrev_b32 v182, 16, v79
    v_and_b32 v183, s37, v79
    v_pk_mul_f32 v[176:177], v[176:177], s[34:35]
    v_pk_mul_f32 v[178:179], v[178:179], s[34:35]
    v_pk_mul_f32 v[180:181], v[180:181], s[34:35]
    v_pk_mul_f32 v[182:183], v[182:183], s[34:35]
    v_cvt_pk_bf16_f32 v184, v176, v177
    v_cvt_pk_bf16_f32 v185, v178, v179
    v_cvt_pk_bf16_f32 v186, v180, v181
    v_cvt_pk_bf16_f32 v187, v182, v183
    v_accvgpr_write_b32 a44, v184
    v_accvgpr_write_b32 a45, v185
    v_accvgpr_write_b32 a46, v186
    v_accvgpr_write_b32 a47, v187
    v_mfma_f32_16x16x32_bf16 v[44:47], a[152:155], a[40:43], v[44:47]
    s_waitcnt vmcnt(10)
    ds_read_b128 v[64:67], v26 offset:4224
    ds_read_b128 v[68:71], v27 offset:4224
    s_add_u32 m0, s28, 16896
    s_mov_b32 s30, 16384
    buffer_load_dwordx4 v5, s[12:15], s30 offen offset:0 nt lds
    buffer_load_dwordx4 v6, s[12:15], s30 offen offset:1056 nt lds
    s_waitcnt lgkmcnt(1)
    v_lshlrev_b32 v160, 16, v64
    v_and_b32 v161, s37, v64
    v_lshlrev_b32 v162, 16, v65
    v_and_b32 v163, s37, v65
    v_lshlrev_b32 v164, 16, v66
    v_and_b32 v165, s37, v66
    v_lshlrev_b32 v166, 16, v67
    v_and_b32 v167, s37, v67
    v_pk_mul_f32 v[160:161], v[160:161], s[34:35]
    v_pk_mul_f32 v[162:163], v[162:163], s[34:35]
    v_pk_mul_f32 v[164:165], v[164:165], s[34:35]
    v_pk_mul_f32 v[166:167], v[166:167], s[34:35]
    v_cvt_pk_bf16_f32 v168, v160, v161
    v_cvt_pk_bf16_f32 v169, v162, v163
    v_cvt_pk_bf16_f32 v170, v164, v165
    v_cvt_pk_bf16_f32 v171, v166, v167
    v_accvgpr_write_b32 a48, v168
    v_accvgpr_write_b32 a49, v169
    v_accvgpr_write_b32 a50, v170
    v_accvgpr_write_b32 a51, v171
    v_mfma_f32_16x16x32_bf16 v[44:47], a[156:159], a[44:47], v[44:47]
    s_waitcnt lgkmcnt(0)
    v_lshlrev_b32 v176, 16, v68
    v_and_b32 v177, s37, v68
    v_lshlrev_b32 v178, 16, v69
    v_and_b32 v179, s37, v69
    v_lshlrev_b32 v180, 16, v70
    v_and_b32 v181, s37, v70
    v_lshlrev_b32 v182, 16, v71
    v_and_b32 v183, s37, v71
    v_pk_mul_f32 v[176:177], v[176:177], s[34:35]
    v_pk_mul_f32 v[178:179], v[178:179], s[34:35]
    v_pk_mul_f32 v[180:181], v[180:181], s[34:35]
    v_pk_mul_f32 v[182:183], v[182:183], s[34:35]
    v_cvt_pk_bf16_f32 v184, v176, v177
    v_cvt_pk_bf16_f32 v185, v178, v179
    v_cvt_pk_bf16_f32 v186, v180, v181
    v_cvt_pk_bf16_f32 v187, v182, v183
    v_accvgpr_write_b32 a52, v184
    v_accvgpr_write_b32 a53, v185
    v_accvgpr_write_b32 a54, v186
    v_accvgpr_write_b32 a55, v187
    v_mfma_f32_16x16x32_bf16 v[44:47], a[160:163], a[48:51], v[44:47]
    s_waitcnt vmcnt(10)
    ds_read_b128 v[72:75], v26 offset:6336
    ds_read_b128 v[76:79], v27 offset:6336
    v_add_u32 v26, 33792, v26
    v_add_u32 v27, 33792, v27
    buffer_load_dwordx4 v7, s[12:15], s30 offen offset:2112 nt lds
    buffer_load_dwordx4 v8, s[12:15], s30 offen offset:3168 nt lds
    s_waitcnt lgkmcnt(1)
    v_lshlrev_b32 v160, 16, v72
    v_and_b32 v161, s37, v72
    v_lshlrev_b32 v162, 16, v73
    v_and_b32 v163, s37, v73
    v_lshlrev_b32 v164, 16, v74
    v_and_b32 v165, s37, v74
    v_lshlrev_b32 v166, 16, v75
    v_and_b32 v167, s37, v75
    v_pk_mul_f32 v[160:161], v[160:161], s[34:35]
    v_pk_mul_f32 v[162:163], v[162:163], s[34:35]
    v_pk_mul_f32 v[164:165], v[164:165], s[34:35]
    v_pk_mul_f32 v[166:167], v[166:167], s[34:35]
    v_cvt_pk_bf16_f32 v168, v160, v161
    v_cvt_pk_bf16_f32 v169, v162, v163
    v_cvt_pk_bf16_f32 v170, v164, v165
    v_cvt_pk_bf16_f32 v171, v166, v167
    v_accvgpr_write_b32 a56, v168
    v_accvgpr_write_b32 a57, v169
    v_accvgpr_write_b32 a58, v170
    v_accvgpr_write_b32 a59, v171
    v_mfma_f32_16x16x32_bf16 v[44:47], a[164:167], a[52:55], v[44:47]
    s_waitcnt lgkmcnt(0)
    v_lshlrev_b32 v176, 16, v76
    v_and_b32 v177, s37, v76
    v_lshlrev_b32 v178, 16, v77
    v_and_b32 v179, s37, v77
    v_lshlrev_b32 v180, 16, v78
    v_and_b32 v181, s37, v78
    v_lshlrev_b32 v182, 16, v79
    v_and_b32 v183, s37, v79
    v_pk_mul_f32 v[176:177], v[176:177], s[34:35]
    v_pk_mul_f32 v[178:179], v[178:179], s[34:35]
    v_pk_mul_f32 v[180:181], v[180:181], s[34:35]
    v_pk_mul_f32 v[182:183], v[182:183], s[34:35]
    v_cvt_pk_bf16_f32 v184, v176, v177
    v_cvt_pk_bf16_f32 v185, v178, v179
    v_cvt_pk_bf16_f32 v186, v180, v181
    v_cvt_pk_bf16_f32 v187, v182, v183
    v_accvgpr_write_b32 a60, v184
    v_accvgpr_write_b32 a61, v185
    v_accvgpr_write_b32 a62, v186
    v_accvgpr_write_b32 a63, v187
    v_mfma_f32_16x16x32_bf16 v[44:47], a[168:171], a[56:59], v[44:47]
    s_waitcnt vmcnt(10)
    ds_read_b128 v[64:67], v26 offset:0
    ds_read_b128 v[68:71], v27 offset:0
    s_add_u32 m0, s28, 33792
    s_mov_b32 s30, 32768
    buffer_load_dwordx4 v5, s[12:15], s30 offen offset:0 nt lds
    buffer_load_dwordx4 v6, s[12:15], s30 offen offset:1056 nt lds
    s_waitcnt lgkmcnt(1)
    v_lshlrev_b32 v160, 16, v64
    v_and_b32 v161, s37, v64
    v_lshlrev_b32 v162, 16, v65
    v_and_b32 v163, s37, v65
    v_lshlrev_b32 v164, 16, v66
    v_and_b32 v165, s37, v66
    v_lshlrev_b32 v166, 16, v67
    v_and_b32 v167, s37, v67
    v_pk_mul_f32 v[160:161], v[160:161], s[34:35]
    v_pk_mul_f32 v[162:163], v[162:163], s[34:35]
    v_pk_mul_f32 v[164:165], v[164:165], s[34:35]
    v_pk_mul_f32 v[166:167], v[166:167], s[34:35]
    v_cvt_pk_bf16_f32 v168, v160, v161
    v_cvt_pk_bf16_f32 v169, v162, v163
    v_cvt_pk_bf16_f32 v170, v164, v165
    v_cvt_pk_bf16_f32 v171, v166, v167
    v_accvgpr_write_b32 a64, v168
    v_accvgpr_write_b32 a65, v169
    v_accvgpr_write_b32 a66, v170
    v_accvgpr_write_b32 a67, v171
    v_mfma_f32_16x16x32_bf16 v[44:47], a[172:175], a[60:63], v[44:47]
    s_waitcnt lgkmcnt(0)
    v_lshlrev_b32 v176, 16, v68
    v_and_b32 v177, s37, v68
    v_lshlrev_b32 v178, 16, v69
    v_and_b32 v179, s37, v69
    v_lshlrev_b32 v180, 16, v70
    v_and_b32 v181, s37, v70
    v_lshlrev_b32 v182, 16, v71
    v_and_b32 v183, s37, v71
    v_pk_mul_f32 v[176:177], v[176:177], s[34:35]
    v_pk_mul_f32 v[178:179], v[178:179], s[34:35]
    v_pk_mul_f32 v[180:181], v[180:181], s[34:35]
    v_pk_mul_f32 v[182:183], v[182:183], s[34:35]
    v_cvt_pk_bf16_f32 v184, v176, v177
    v_cvt_pk_bf16_f32 v185, v178, v179
    v_cvt_pk_bf16_f32 v186, v180, v181
    v_cvt_pk_bf16_f32 v187, v182, v183
    v_accvgpr_write_b32 a68, v184
    v_accvgpr_write_b32 a69, v185
    v_accvgpr_write_b32 a70, v186
    v_accvgpr_write_b32 a71, v187
    v_mfma_f32_16x16x32_bf16 v[48:51], a[144:147], a[64:67], 0
    v_max3_f32 v24, v44, v45, v46
    v_max_f32 v24, v24, v47
    v_mov_b32 v25, v24
    s_nop 1
    v_permlane32_swap_b32 v24, v25
    s_nop 1
    v_max_f32 v24, v24, v25
    v_mov_b32 v25, v24
    s_nop 1
    v_permlane16_swap_b32 v24, v25
    s_nop 1
    v_max_f32 v24, v24, v25
    v_sub_f32 v32, 0, v24
    v_sub_f32 v33, 0, v24
    v_sub_f32 v34, 0, v24
    v_sub_f32 v35, 0, v24
    v_add_f32 v44, v32, v44
    v_add_f32 v45, v33, v45
    v_add_f32 v46, v34, v46
    v_add_f32 v47, v35, v47
    s_waitcnt vmcnt(10)
    ds_read_b128 v[72:75], v26 offset:2112
    ds_read_b128 v[76:79], v27 offset:2112
    buffer_load_dwordx4 v7, s[12:15], s30 offen offset:2112 nt lds
    buffer_load_dwordx4 v8, s[12:15], s30 offen offset:3168 nt lds
    s_waitcnt lgkmcnt(1)
    v_lshlrev_b32 v160, 16, v72
    v_and_b32 v161, s37, v72
    v_lshlrev_b32 v162, 16, v73
    v_and_b32 v163, s37, v73
    v_lshlrev_b32 v164, 16, v74
    v_and_b32 v165, s37, v74
    v_lshlrev_b32 v166, 16, v75
    v_and_b32 v167, s37, v75
    v_pk_mul_f32 v[160:161], v[160:161], s[34:35]
    v_pk_mul_f32 v[162:163], v[162:163], s[34:35]
    v_pk_mul_f32 v[164:165], v[164:165], s[34:35]
    v_pk_mul_f32 v[166:167], v[166:167], s[34:35]
    v_cvt_pk_bf16_f32 v168, v160, v161
    v_cvt_pk_bf16_f32 v169, v162, v163
    v_cvt_pk_bf16_f32 v170, v164, v165
    v_cvt_pk_bf16_f32 v171, v166, v167
    v_accvgpr_write_b32 a72, v168
    v_accvgpr_write_b32 a73, v169
    v_accvgpr_write_b32 a74, v170
    v_accvgpr_write_b32 a75, v171
    v_mfma_f32_16x16x32_bf16 v[48:51], a[148:151], a[68:71], v[48:51]
    s_waitcnt lgkmcnt(0)
    v_lshlrev_b32 v176, 16, v76
    v_and_b32 v177, s37, v76
    v_lshlrev_b32 v178, 16, v77
    v_and_b32 v179, s37, v77
    v_lshlrev_b32 v180, 16, v78
    v_and_b32 v181, s37, v78
    v_lshlrev_b32 v182, 16, v79
    v_and_b32 v183, s37, v79
    v_pk_mul_f32 v[176:177], v[176:177], s[34:35]
    v_pk_mul_f32 v[178:179], v[178:179], s[34:35]
    v_pk_mul_f32 v[180:181], v[180:181], s[34:35]
    v_pk_mul_f32 v[182:183], v[182:183], s[34:35]
    v_cvt_pk_bf16_f32 v184, v176, v177
    v_cvt_pk_bf16_f32 v185, v178, v179
    v_cvt_pk_bf16_f32 v186, v180, v181
    v_cvt_pk_bf16_f32 v187, v182, v183
    v_accvgpr_write_b32 a76, v184
    v_accvgpr_write_b32 a77, v185
    v_accvgpr_write_b32 a78, v186
    v_accvgpr_write_b32 a79, v187
    v_mfma_f32_16x16x32_bf16 v[48:51], a[152:155], a[72:75], v[48:51]
    s_waitcnt vmcnt(10)
    ds_read_b128 v[64:67], v26 offset:4224
    ds_read_b128 v[68:71], v27 offset:4224
    s_waitcnt lgkmcnt(1)
    v_lshlrev_b32 v160, 16, v64
    v_and_b32 v161, s37, v64
    v_lshlrev_b32 v162, 16, v65
    v_and_b32 v163, s37, v65
    v_lshlrev_b32 v164, 16, v66
    v_and_b32 v165, s37, v66
    v_lshlrev_b32 v166, 16, v67
    v_and_b32 v167, s37, v67
    v_pk_mul_f32 v[160:161], v[160:161], s[34:35]
    v_pk_mul_f32 v[162:163], v[162:163], s[34:35]
    v_pk_mul_f32 v[164:165], v[164:165], s[34:35]
    v_pk_mul_f32 v[166:167], v[166:167], s[34:35]
    v_cvt_pk_bf16_f32 v168, v160, v161
    v_cvt_pk_bf16_f32 v169, v162, v163
    v_cvt_pk_bf16_f32 v170, v164, v165
    v_cvt_pk_bf16_f32 v171, v166, v167
    v_accvgpr_write_b32 a80, v168
    v_accvgpr_write_b32 a81, v169
    v_accvgpr_write_b32 a82, v170
    v_accvgpr_write_b32 a83, v171
    v_mfma_f32_16x16x32_bf16 v[48:51], a[156:159], a[76:79], v[48:51]
    s_waitcnt lgkmcnt(0)
    v_lshlrev_b32 v176, 16, v68
    v_and_b32 v177, s37, v68
    v_lshlrev_b32 v178, 16, v69
    v_and_b32 v179, s37, v69
    v_lshlrev_b32 v180, 16, v70
    v_and_b32 v181, s37, v70
    v_lshlrev_b32 v182, 16, v71
    v_and_b32 v183, s37, v71
    v_pk_mul_f32 v[176:177], v[176:177], s[34:35]
    v_pk_mul_f32 v[178:179], v[178:179], s[34:35]
    v_pk_mul_f32 v[180:181], v[180:181], s[34:35]
    v_pk_mul_f32 v[182:183], v[182:183], s[34:35]
    v_cvt_pk_bf16_f32 v184, v176, v177
    v_cvt_pk_bf16_f32 v185, v178, v179
    v_cvt_pk_bf16_f32 v186, v180, v181
    v_cvt_pk_bf16_f32 v187, v182, v183
    v_accvgpr_write_b32 a84, v184
    v_accvgpr_write_b32 a85, v185
    v_accvgpr_write_b32 a86, v186
    v_accvgpr_write_b32 a87, v187
    v_mfma_f32_16x16x32_bf16 v[48:51], a[160:163], a[80:83], v[48:51]
    s_waitcnt vmcnt(8)
    ds_read_b128 v[72:75], v26 offset:6336
    ds_read_b128 v[76:79], v27 offset:6336
    s_waitcnt lgkmcnt(1)
    v_lshlrev_b32 v160, 16, v72
    v_and_b32 v161, s37, v72
    v_lshlrev_b32 v162, 16, v73
    v_and_b32 v163, s37, v73
    v_lshlrev_b32 v164, 16, v74
    v_and_b32 v165, s37, v74
    v_lshlrev_b32 v166, 16, v75
    v_and_b32 v167, s37, v75
    v_pk_mul_f32 v[160:161], v[160:161], s[34:35]
    v_pk_mul_f32 v[162:163], v[162:163], s[34:35]
    v_pk_mul_f32 v[164:165], v[164:165], s[34:35]
    v_pk_mul_f32 v[166:167], v[166:167], s[34:35]
    v_cvt_pk_bf16_f32 v168, v160, v161
    v_cvt_pk_bf16_f32 v169, v162, v163
    v_cvt_pk_bf16_f32 v170, v164, v165
    v_cvt_pk_bf16_f32 v171, v166, v167
    v_accvgpr_write_b32 a88, v168
    v_accvgpr_write_b32 a89, v169
    v_accvgpr_write_b32 a90, v170
    v_accvgpr_write_b32 a91, v171
    v_mfma_f32_16x16x32_bf16 v[48:51], a[164:167], a[84:87], v[48:51]
    s_waitcnt lgkmcnt(0)
    v_lshlrev_b32 v176, 16, v76
    v_and_b32 v177, s37, v76
    v_lshlrev_b32 v178, 16, v77
    v_and_b32 v179, s37, v77
    v_lshlrev_b32 v180, 16, v78
    v_and_b32 v181, s37, v78
    v_lshlrev_b32 v182, 16, v79
    v_and_b32 v183, s37, v79
    v_pk_mul_f32 v[176:177], v[176:177], s[34:35]
    v_pk_mul_f32 v[178:179], v[178:179], s[34:35]
    v_pk_mul_f32 v[180:181], v[180:181], s[34:35]
    v_pk_mul_f32 v[182:183], v[182:183], s[34:35]
    v_cvt_pk_bf16_f32 v184, v176, v177
    v_cvt_pk_bf16_f32 v185, v178, v179
    v_cvt_pk_bf16_f32 v186, v180, v181
    v_cvt_pk_bf16_f32 v187, v182, v183
    v_accvgpr_write_b32 a92, v184
    v_accvgpr_write_b32 a93, v185
    v_accvgpr_write_b32 a94, v186
    v_accvgpr_write_b32 a95, v187
    v_mfma_f32_16x16x32_bf16 v[48:51], a[168:171], a[88:91], v[48:51]
    s_nop 1
    v_mfma_f32_16x16x32_bf16 v[48:51], a[172:175], a[92:95], v[48:51]
    s_nop 7
    v_max3_f32 v24, v48, v49, v50
    v_max_f32 v24, v24, v51
    v_mov_b32 v25, v24
    s_nop 1
    v_permlane32_swap_b32 v24, v25
    s_nop 1
    v_max_f32 v24, v24, v25
    v_mov_b32 v25, v24
    s_nop 1
    v_permlane16_swap_b32 v24, v25
    s_nop 1
    v_max_f32 v24, v24, v25
    v_sub_f32 v36, 0, v24
    v_sub_f32 v37, 0, v24
    v_sub_f32 v38, 0, v24
    v_sub_f32 v39, 0, v24
    v_add_f32 v48, v36, v48
    v_add_f32 v49, v37, v49
    v_add_f32 v50, v38, v50
    v_add_f32 v51, v39, v51
    s_waitcnt lgkmcnt(15)
L_join:
    v_mfma_f32_16x16x32_bf16 v[52:55], a[176:179], a[0:3], v[28:31]
    ds_read_b128 a[200:203], v2 offset:8832
    ds_read_b128 a[204:207], v2 offset:8896
    s_add_u32 m0, s28, 50688
    v_mfma_f32_16x16x32_bf16 v[56:59], a[176:179], a[32:35], v[32:35]
    s_mov_b32 s30, 49152
    v_exp_f32 v40, v40
    v_mfma_f32_16x16x32_bf16 v[60:63], a[176:179], a[64:67], v[36:39]
    v_exp_f32 v41, v41
    v_mfma_f32_16x16x32_bf16 v[52:55], a[180:183], a[4:7], v[52:55]
    s_waitcnt vmcnt(4)
    s_barrier
    v_mfma_f32_16x16x32_bf16 v[56:59], a[180:183], a[36:39], v[56:59]
    v_exp_f32 v42, v42
    v_mfma_f32_16x16x32_bf16 v[60:63], a[180:183], a[68:71], v[60:63]
    v_cvt_pk_bf16_f32 v64, v40, v41
    s_waitcnt lgkmcnt(15)
    v_mfma_f32_16x16x32_bf16 v[52:55], a[184:187], a[8:11], v[52:55]
    ds_read_b128 a[144:147], v2 offset:16896
    ds_read_b128 a[148:151], v2 offset:16960
    v_mfma_f32_16x16x32_bf16 v[56:59], a[184:187], a[40:43], v[56:59]
    v_exp_f32 v43, v43
    v_mfma_f32_16x16x32_bf16 v[60:63], a[184:187], a[72:75], v[60:63]
    v_exp_f32 v44, v44
    v_mfma_f32_16x16x32_bf16 v[52:55], a[188:191], a[12:15], v[52:55]
    buffer_load_dwordx4 v5, s[12:15], s30 offen offset:0 nt lds
    v_mfma_f32_16x16x32_bf16 v[56:59], a[188:191], a[44:47], v[56:59]
    v_exp_f32 v45, v45
    v_mfma_f32_16x16x32_bf16 v[60:63], a[188:191], a[76:79], v[60:63]
    v_cvt_pk_bf16_f32 v65, v42, v43
    s_waitcnt lgkmcnt(15)
    v_mfma_f32_16x16x32_bf16 v[52:55], a[192:195], a[16:19], v[52:55]
    ds_read_b128 a[152:155], v2 offset:17024
    ds_read_b128 a[156:159], v2 offset:17088
    v_mfma_f32_16x16x32_bf16 v[56:59], a[192:195], a[48:51], v[56:59]
    v_exp_f32 v46, v46
    v_mfma_f32_16x16x32_bf16 v[60:63], a[192:195], a[80:83], v[60:63]
    v_exp_f32 v47, v47
    v_mfma_f32_16x16x32_bf16 v[52:55], a[196:199], a[20:23], v[52:55]
    buffer_load_dwordx4 v6, s[12:15], s30 offen offset:1056 nt lds
    v_mfma_f32_16x16x32_bf16 v[56:59], a[196:199], a[52:55], v[56:59]
    v_exp_f32 v48, v48
    v_mfma_f32_16x16x32_bf16 v[60:63], a[196:199], a[84:87], v[60:63]
    v_cvt_pk_bf16_f32 v68, v44, v45
    s_waitcnt lgkmcnt(4)
    v_mfma_f32_16x16x32_bf16 v[52:55], a[200:203], a[24:27], v[52:55]
    ds_read_b128 a[160:163], v2 offset:17152
    ds_read_b128 a[164:167], v2 offset:17216
    v_mfma_f32_16x16x32_bf16 v[56:59], a[200:203], a[56:59], v[56:59]
    v_exp_f32 v49, v49
    v_mfma_f32_16x16x32_bf16 v[60:63], a[200:203], a[88:91], v[60:63]
    v_exp_f32 v50, v50
    v_mfma_f32_16x16x32_bf16 v[52:55], a[204:207], a[28:31], v[52:55]
    v_cvt_pk_bf16_f32 v69, v46, v47
    v_cvt_pk_bf16_f32 v72, v48, v49
    v_mfma_f32_16x16x32_bf16 v[56:59], a[204:207], a[60:63], v[56:59]
    v_exp_f32 v51, v51
    v_mfma_f32_16x16x32_bf16 v[60:63], a[204:207], a[92:95], v[60:63]
    v_cvt_pk_bf16_f32 v73, v50, v51
    s_waitcnt lgkmcnt(4)
    v_mfma_f32_16x16x32_bf16 v[40:43], a[144:147], a[0:3], v[28:31]
    ds_read_b128 a[168:171], v2 offset:17280
    ds_read_b128 a[172:175], v2 offset:17344
    v_mfma_f32_16x16x32_bf16 v[44:47], a[144:147], a[32:35], v[32:35]
    v_exp_f32 v52, v52
    v_mfma_f32_16x16x32_bf16 v[48:51], a[144:147], a[64:67], v[36:39]
    v_exp_f32 v53, v53
    v_mfma_f32_16x16x32_bf16 v[40:43], a[148:151], a[4:7], v[40:43]
    buffer_load_dwordx4 v7, s[12:15], s30 offen offset:2112 nt lds
    v_mfma_f32_16x16x32_bf16 v[44:47], a[148:151], a[36:39], v[44:47]
    v_exp_f32 v54, v54
    v_mfma_f32_16x16x32_bf16 v[48:51], a[148:151], a[68:71], v[48:51]
    v_cvt_pk_bf16_f32 v66, v52, v53
    s_waitcnt lgkmcnt(4)
    v_mfma_f32_16x16x32_bf16 v[40:43], a[152:155], a[8:11], v[40:43]
    ds_read_b128 a[176:179], v2 offset:25344
    ds_read_b128 a[180:183], v2 offset:25408
    v_mfma_f32_16x16x32_bf16 v[44:47], a[152:155], a[40:43], v[44:47]
    v_exp_f32 v55, v55
    v_mfma_f32_16x16x32_bf16 v[48:51], a[152:155], a[72:75], v[48:51]
    v_exp_f32 v56, v56
    v_mfma_f32_16x16x32_bf16 v[40:43], a[156:159], a[12:15], v[40:43]
    v_cvt_pk_bf16_f32 v67, v54, v55
    v_mfma_f32_16x16x32_bf16 v[44:47], a[156:159], a[44:47], v[44:47]
    v_exp_f32 v57, v57
    v_mfma_f32_16x16x32_bf16 v[48:51], a[156:159], a[76:79], v[48:51]
    v_cvt_pk_bf16_f32 v70, v56, v57
    s_waitcnt lgkmcnt(4)
    v_mfma_f32_16x16x32_bf16 v[40:43], a[160:163], a[16:19], v[40:43]
    ds_read_b128 a[184:187], v2 offset:25472
    ds_read_b128 a[188:191], v2 offset:25536
    v_mfma_f32_16x16x32_bf16 v[44:47], a[160:163], a[48:51], v[44:47]
    v_exp_f32 v58, v58
    v_mfma_f32_16x16x32_bf16 v[48:51], a[160:163], a[80:83], v[48:51]
    v_exp_f32 v59, v59
    v_mfma_f32_16x16x32_bf16 v[40:43], a[164:167], a[20:23], v[40:43]
    buffer_load_dwordx4 v8, s[12:15], s30 offen offset:3168 nt lds
    v_mfma_f32_16x16x32_bf16 v[44:47], a[164:167], a[52:55], v[44:47]
    v_exp_f32 v60, v60
    v_mfma_f32_16x16x32_bf16 v[48:51], a[164:167], a[84:87], v[48:51]
    v_cvt_pk_bf16_f32 v71, v58, v59
    s_waitcnt lgkmcnt(4)
    v_mfma_f32_16x16x32_bf16 v[40:43], a[168:171], a[24:27], v[40:43]
    ds_read_b128 a[192:195], v2 offset:25600
    ds_read_b128 a[196:199], v2 offset:25664
    v_mfma_f32_16x16x32_bf16 v[44:47], a[168:171], a[56:59], v[44:47]
    v_exp_f32 v61, v61
    v_mfma_f32_16x16x32_bf16 v[48:51], a[168:171], a[88:91], v[48:51]
    v_exp_f32 v62, v62
    v_mfma_f32_16x16x32_bf16 v[40:43], a[172:175], a[28:31], v[40:43]
    v_cvt_pk_bf16_f32 v74, v60, v61
    v_mfma_f32_16x16x32_bf16 v[44:47], a[172:175], a[60:63], v[44:47]
    v_exp_f32 v63, v63
    v_mfma_f32_16x16x32_bf16 v[48:51], a[172:175], a[92:95], v[48:51]
    v_cvt_pk_bf16_f32 v75, v62, v63
    s_waitcnt lgkmcnt(4)
    v_mfma_f32_16x16x32_bf16 a[128:131], a[140:143], v[64:67], 0
    s_add_u32 m0, s28, 67584
    s_mov_b32 s30, 65536
    v_mfma_f32_16x16x32_bf16 a[132:135], a[140:143], v[68:71], 0
    v_mfma_f32_16x16x32_bf16 a[136:139], a[140:143], v[72:75], 0
    v_mfma_f32_16x16x32_bf16 v[52:55], a[176:179], a[0:3], v[28:31]
    ds_read_b128 a[200:203], v2 offset:25728
    ds_read_b128 a[204:207], v2 offset:25792
    v_mfma_f32_16x16x32_bf16 v[56:59], a[176:179], a[32:35], v[32:35]
    v_exp_f32 v40, v40
    v_mfma_f32_16x16x32_bf16 v[60:63], a[176:179], a[64:67], v[36:39]
    v_exp_f32 v41, v41
    v_mfma_f32_16x16x32_bf16 v[52:55], a[180:183], a[4:7], v[52:55]
    s_waitcnt vmcnt(4)
    s_barrier
    v_mfma_f32_16x16x32_bf16 v[56:59], a[180:183], a[36:39], v[56:59]
    v_exp_f32 v42, v42
    v_mfma_f32_16x16x32_bf16 v[60:63], a[180:183], a[68:71], v[60:63]
    v_cvt_pk_bf16_f32 v76, v40, v41
    s_waitcnt lgkmcnt(4)
    v_mfma_f32_16x16x32_bf16 v[52:55], a[184:187], a[8:11], v[52:55]
    ds_read_b128 a[144:147], v2 offset:33792
    ds_read_b128 a[148:151], v2 offset:33856
    v_mfma_f32_16x16x32_bf16 v[56:59], a[184:187], a[40:43], v[56:59]
    v_exp_f32 v43, v43
    v_mfma_f32_16x16x32_bf16 v[60:63], a[184:187], a[72:75], v[60:63]
    v_exp_f32 v44, v44
    v_mfma_f32_16x16x32_bf16 v[52:55], a[188:191], a[12:15], v[52:55]
    buffer_load_dwordx4 v5, s[12:15], s30 offen offset:0 nt lds
    v_mfma_f32_16x16x32_bf16 v[56:59], a[188:191], a[44:47], v[56:59]
    v_exp_f32 v45, v45
    v_mfma_f32_16x16x32_bf16 v[60:63], a[188:191], a[76:79], v[60:63]
    v_cvt_pk_bf16_f32 v77, v42, v43
    s_waitcnt lgkmcnt(4)
    v_mfma_f32_16x16x32_bf16 v[52:55], a[192:195], a[16:19], v[52:55]
    ds_read_b128 a[152:155], v2 offset:33920
    ds_read_b128 a[156:159], v2 offset:33984
    v_mfma_f32_16x16x32_bf16 v[56:59], a[192:195], a[48:51], v[56:59]
    v_exp_f32 v46, v46
    v_mfma_f32_16x16x32_bf16 v[60:63], a[192:195], a[80:83], v[60:63]
    v_exp_f32 v47, v47
    v_mfma_f32_16x16x32_bf16 v[52:55], a[196:199], a[20:23], v[52:55]
    buffer_load_dwordx4 v6, s[12:15], s30 offen offset:1056 nt lds
    v_mfma_f32_16x16x32_bf16 v[56:59], a[196:199], a[52:55], v[56:59]
    v_exp_f32 v48, v48
    v_mfma_f32_16x16x32_bf16 v[60:63], a[196:199], a[84:87], v[60:63]
    v_cvt_pk_bf16_f32 v80, v44, v45
    s_waitcnt lgkmcnt(4)
    v_mfma_f32_16x16x32_bf16 v[52:55], a[200:203], a[24:27], v[52:55]
    ds_read_b128 a[160:163], v2 offset:34048
    ds_read_b128 a[164:167], v2 offset:34112
    v_mfma_f32_16x16x32_bf16 v[56:59], a[200:203], a[56:59], v[56:59]
    v_exp_f32 v49, v49
    v_mfma_f32_16x16x32_bf16 v[60:63], a[200:203], a[88:91], v[60:63]
    v_exp_f32 v50, v50
    v_mfma_f32_16x16x32_bf16 v[52:55], a[204:207], a[28:31], v[52:55]
    v_cvt_pk_bf16_f32 v81, v46, v47
    v_cvt_pk_bf16_f32 v84, v48, v49
    v_mfma_f32_16x16x32_bf16 v[56:59], a[204:207], a[60:63], v[56:59]
    v_exp_f32 v51, v51
    v_mfma_f32_16x16x32_bf16 v[60:63], a[204:207], a[92:95], v[60:63]
    v_cvt_pk_bf16_f32 v85, v50, v51
    s_waitcnt lgkmcnt(4)
    v_mfma_f32_16x16x32_bf16 v[40:43], a[144:147], a[0:3], v[28:31]
    ds_read_b128 a[168:171], v2 offset:34176
    ds_read_b128 a[172:175], v2 offset:34240
    v_mfma_f32_16x16x32_bf16 v[44:47], a[144:147], a[32:35], v[32:35]
    v_exp_f32 v52, v52
    v_mfma_f32_16x16x32_bf16 v[48:51], a[144:147], a[64:67], v[36:39]
    v_exp_f32 v53, v53
    v_mfma_f32_16x16x32_bf16 v[40:43], a[148:151], a[4:7], v[40:43]
    buffer_load_dwordx4 v7, s[12:15], s30 offen offset:2112 nt lds
    v_mfma_f32_16x16x32_bf16 v[44:47], a[148:151], a[36:39], v[44:47]
    v_exp_f32 v54, v54
    v_mfma_f32_16x16x32_bf16 v[48:51], a[148:151], a[68:71], v[48:51]
    v_cvt_pk_bf16_f32 v78, v52, v53
    s_waitcnt lgkmcnt(4)
    v_mfma_f32_16x16x32_bf16 v[40:43], a[152:155], a[8:11], v[40:43]
    ds_read_b128 a[176:179], v2 offset:42240
    ds_read_b128 a[180:183], v2 offset:42304
    v_mfma_f32_16x16x32_bf16 v[44:47], a[152:155], a[40:43], v[44:47]
    v_exp_f32 v55, v55
    v_mfma_f32_16x16x32_bf16 v[48:51], a[152:155], a[72:75], v[48:51]
    v_exp_f32 v56, v56
    v_mfma_f32_16x16x32_bf16 v[40:43], a[156:159], a[12:15], v[40:43]
    v_cvt_pk_bf16_f32 v79, v54, v55
    v_mfma_f32_16x16x32_bf16 v[44:47], a[156:159], a[44:47], v[44:47]
    v_exp_f32 v57, v57
    v_mfma_f32_16x16x32_bf16 v[48:51], a[156:159], a[76:79], v[48:51]
    v_cvt_pk_bf16_f32 v82, v56, v57
    s_waitcnt lgkmcnt(4)
    v_mfma_f32_16x16x32_bf16 v[40:43], a[160:163], a[16:19], v[40:43]
    ds_read_b128 a[184:187], v2 offset:42368
    ds_read_b128 a[188:191], v2 offset:42432
    v_mfma_f32_16x16x32_bf16 v[44:47], a[160:163], a[48:51], v[44:47]
    v_exp_f32 v58, v58
    v_mfma_f32_16x16x32_bf16 v[48:51], a[160:163], a[80:83], v[48:51]
    v_exp_f32 v59, v59
    v_mfma_f32_16x16x32_bf16 v[40:43], a[164:167], a[20:23], v[40:43]
    buffer_load_dwordx4 v8, s[12:15], s30 offen offset:3168 nt lds
    v_mfma_f32_16x16x32_bf16 v[44:47], a[164:167], a[52:55], v[44:47]
    v_exp_f32 v60, v60
    v_mfma_f32_16x16x32_bf16 v[48:51], a[164:167], a[84:87], v[48:51]
    v_cvt_pk_bf16_f32 v83, v58, v59
    s_waitcnt lgkmcnt(4)
    v_mfma_f32_16x16x32_bf16 v[40:43], a[168:171], a[24:27], v[40:43]
    ds_read_b128 a[192:195], v2 offset:42496
    ds_read_b128 a[196:199], v2 offset:42560
    v_mfma_f32_16x16x32_bf16 v[44:47], a[168:171], a[56:59], v[44:47]
    v_exp_f32 v61, v61
    v_mfma_f32_16x16x32_bf16 v[48:51], a[168:171], a[88:91], v[48:51]
    v_exp_f32 v62, v62
    v_mfma_f32_16x16x32_bf16 v[40:43], a[172:175], a[28:31], v[40:43]
    v_cvt_pk_bf16_f32 v86, v60, v61
    v_mfma_f32_16x16x32_bf16 v[44:47], a[172:175], a[60:63], v[44:47]
    v_exp_f32 v63, v63
    v_mfma_f32_16x16x32_bf16 v[48:51], a[172:175], a[92:95], v[48:51]
    v_cvt_pk_bf16_f32 v87, v62, v63
    s_waitcnt lgkmcnt(4)
    v_mfma_f32_16x16x32_bf16 a[128:131], a[140:143], v[76:79], a[128:131]
    s_add_u32 m0, s28, 84480
    s_mov_b32 s30, 81920
    v_mfma_f32_16x16x32_bf16 a[132:135], a[140:143], v[80:83], a[132:135]
    v_mfma_f32_16x16x32_bf16 a[136:139], a[140:143], v[84:87], a[136:139]
    v_mfma_f32_16x16x32_bf16 v[52:55], a[176:179], a[0:3], v[28:31]
    ds_read_b128 a[200:203], v2 offset:42624
    ds_read_b128 a[204:207], v2 offset:42688
    v_mfma_f32_16x16x32_bf16 v[56:59], a[176:179], a[32:35], v[32:35]
    v_exp_f32 v40, v40
    v_mfma_f32_16x16x32_bf16 v[60:63], a[176:179], a[64:67], v[36:39]
    v_exp_f32 v41, v41
    v_mfma_f32_16x16x32_bf16 v[52:55], a[180:183], a[4:7], v[52:55]
    s_waitcnt vmcnt(4)
    s_barrier
    v_mfma_f32_16x16x32_bf16 v[56:59], a[180:183], a[36:39], v[56:59]
    v_exp_f32 v42, v42
    v_mfma_f32_16x16x32_bf16 v[60:63], a[180:183], a[68:71], v[60:63]
    v_cvt_pk_bf16_f32 v88, v40, v41
    s_waitcnt lgkmcnt(4)
    v_mfma_f32_16x16x32_bf16 v[52:55], a[184:187], a[8:11], v[52:55]
    ds_read_b128 a[144:147], v3 offset:0
    ds_read_b128 a[148:151], v3 offset:64
    v_mfma_f32_16x16x32_bf16 v[56:59], a[184:187], a[40:43], v[56:59]
    v_exp_f32 v43, v43
    v_mfma_f32_16x16x32_bf16 v[60:63], a[184:187], a[72:75], v[60:63]
    v_exp_f32 v44, v44
    v_mfma_f32_16x16x32_bf16 v[52:55], a[188:191], a[12:15], v[52:55]
    buffer_load_dwordx4 v5, s[12:15], s30 offen offset:0 nt lds
    v_mfma_f32_16x16x32_bf16 v[56:59], a[188:191], a[44:47], v[56:59]
    v_exp_f32 v45, v45
    v_mfma_f32_16x16x32_bf16 v[60:63], a[188:191], a[76:79], v[60:63]
    v_cvt_pk_bf16_f32 v89, v42, v43
    s_waitcnt lgkmcnt(4)
    v_mfma_f32_16x16x32_bf16 v[52:55], a[192:195], a[16:19], v[52:55]
    ds_read_b128 a[152:155], v3 offset:128
    ds_read_b128 a[156:159], v3 offset:192
    v_mfma_f32_16x16x32_bf16 v[56:59], a[192:195], a[48:51], v[56:59]
    v_exp_f32 v46, v46
    v_mfma_f32_16x16x32_bf16 v[60:63], a[192:195], a[80:83], v[60:63]
    v_exp_f32 v47, v47
    v_mfma_f32_16x16x32_bf16 v[52:55], a[196:199], a[20:23], v[52:55]
    buffer_load_dwordx4 v6, s[12:15], s30 offen offset:1056 nt lds
    v_mfma_f32_16x16x32_bf16 v[56:59], a[196:199], a[52:55], v[56:59]
    v_exp_f32 v48, v48
    v_mfma_f32_16x16x32_bf16 v[60:63], a[196:199], a[84:87], v[60:63]
    v_cvt_pk_bf16_f32 v92, v44, v45
    s_waitcnt lgkmcnt(4)
    v_mfma_f32_16x16x32_bf16 v[52:55], a[200:203], a[24:27], v[52:55]
    ds_read_b128 a[160:163], v3 offset:256
    ds_read_b128 a[164:167], v3 offset:320
    v_mfma_f32_16x16x32_bf16 v[56:59], a[200:203], a[56:59], v[56:59]
    v_exp_f32 v49, v49
    v_mfma_f32_16x16x32_bf16 v[60:63], a[200:203], a[88:91], v[60:63]
    v_exp_f32 v50, v50
    v_mfma_f32_16x16x32_bf16 v[52:55], a[204:207], a[28:31], v[52:55]
    v_cvt_pk_bf16_f32 v93, v46, v47
    v_cvt_pk_bf16_f32 v96, v48, v49
    v_mfma_f32_16x16x32_bf16 v[56:59], a[204:207], a[60:63], v[56:59]
    v_exp_f32 v51, v51
    v_mfma_f32_16x16x32_bf16 v[60:63], a[204:207], a[92:95], v[60:63]
    v_cvt_pk_bf16_f32 v97, v50, v51
    s_waitcnt lgkmcnt(4)
    v_mfma_f32_16x16x32_bf16 v[40:43], a[144:147], a[0:3], v[28:31]
    ds_read_b128 a[168:171], v3 offset:384
    ds_read_b128 a[172:175], v3 offset:448
    v_mfma_f32_16x16x32_bf16 v[44:47], a[144:147], a[32:35], v[32:35]
    v_exp_f32 v52, v52
    v_mfma_f32_16x16x32_bf16 v[48:51], a[144:147], a[64:67], v[36:39]
    v_exp_f32 v53, v53
    v_mfma_f32_16x16x32_bf16 v[40:43], a[148:151], a[4:7], v[40:43]
    buffer_load_dwordx4 v7, s[12:15], s30 offen offset:2112 nt lds
    v_mfma_f32_16x16x32_bf16 v[44:47], a[148:151], a[36:39], v[44:47]
    v_exp_f32 v54, v54
    v_mfma_f32_16x16x32_bf16 v[48:51], a[148:151], a[68:71], v[48:51]
    v_cvt_pk_bf16_f32 v90, v52, v53
    s_waitcnt lgkmcnt(4)
    v_mfma_f32_16x16x32_bf16 v[40:43], a[152:155], a[8:11], v[40:43]
    ds_read_b128 a[176:179], v3 offset:8448
    ds_read_b128 a[180:183], v3 offset:8512
    v_mfma_f32_16x16x32_bf16 v[44:47], a[152:155], a[40:43], v[44:47]
    v_exp_f32 v55, v55
    v_mfma_f32_16x16x32_bf16 v[48:51], a[152:155], a[72:75], v[48:51]
    v_exp_f32 v56, v56
    v_mfma_f32_16x16x32_bf16 v[40:43], a[156:159], a[12:15], v[40:43]
    v_cvt_pk_bf16_f32 v91, v54, v55
    v_mfma_f32_16x16x32_bf16 v[44:47], a[156:159], a[44:47], v[44:47]
    v_exp_f32 v57, v57
    v_mfma_f32_16x16x32_bf16 v[48:51], a[156:159], a[76:79], v[48:51]
    v_cvt_pk_bf16_f32 v94, v56, v57
    s_waitcnt lgkmcnt(4)
    v_mfma_f32_16x16x32_bf16 v[40:43], a[160:163], a[16:19], v[40:43]
    ds_read_b128 a[184:187], v3 offset:8576
    ds_read_b128 a[188:191], v3 offset:8640
    v_mfma_f32_16x16x32_bf16 v[44:47], a[160:163], a[48:51], v[44:47]
    v_exp_f32 v58, v58
    v_mfma_f32_16x16x32_bf16 v[48:51], a[160:163], a[80:83], v[48:51]
    v_exp_f32 v59, v59
    v_mfma_f32_16x16x32_bf16 v[40:43], a[164:167], a[20:23], v[40:43]
    buffer_load_dwordx4 v8, s[12:15], s30 offen offset:3168 nt lds
    v_mfma_f32_16x16x32_bf16 v[44:47], a[164:167], a[52:55], v[44:47]
    v_exp_f32 v60, v60
    v_mfma_f32_16x16x32_bf16 v[48:51], a[164:167], a[84:87], v[48:51]
    v_cvt_pk_bf16_f32 v95, v58, v59
    s_waitcnt lgkmcnt(4)
    v_mfma_f32_16x16x32_bf16 v[40:43], a[168:171], a[24:27], v[40:43]
    ds_read_b128 a[192:195], v3 offset:8704
    ds_read_b128 a[196:199], v3 offset:8768
    v_mfma_f32_16x16x32_bf16 v[44:47], a[168:171], a[56:59], v[44:47]
    v_exp_f32 v61, v61
    v_mfma_f32_16x16x32_bf16 v[48:51], a[168:171], a[88:91], v[48:51]
    v_exp_f32 v62, v62
    v_mfma_f32_16x16x32_bf16 v[40:43], a[172:175], a[28:31], v[40:43]
    v_cvt_pk_bf16_f32 v98, v60, v61
    v_mfma_f32_16x16x32_bf16 v[44:47], a[172:175], a[60:63], v[44:47]
    v_exp_f32 v63, v63
    v_mfma_f32_16x16x32_bf16 v[48:51], a[172:175], a[92:95], v[48:51]
    v_cvt_pk_bf16_f32 v99, v62, v63
    s_waitcnt lgkmcnt(4)
    v_mfma_f32_16x16x32_bf16 a[128:131], a[140:143], v[88:91], a[128:131]
    s_add_u32 m0, s28, 101376
    s_mov_b32 s30, 98304
    v_mfma_f32_16x16x32_bf16 a[132:135], a[140:143], v[92:95], a[132:135]
    v_mfma_f32_16x16x32_bf16 a[136:139], a[140:143], v[96:99], a[136:139]
    v_mfma_f32_16x16x32_bf16 v[52:55], a[176:179], a[0:3], v[28:31]
    ds_read_b128 a[200:203], v3 offset:8832
    ds_read_b128 a[204:207], v3 offset:8896
    v_mfma_f32_16x16x32_bf16 v[56:59], a[176:179], a[32:35], v[32:35]
    v_exp_f32 v40, v40
    v_mfma_f32_16x16x32_bf16 v[60:63], a[176:179], a[64:67], v[36:39]
    v_exp_f32 v41, v41
    v_mfma_f32_16x16x32_bf16 v[52:55], a[180:183], a[4:7], v[52:55]
    s_waitcnt vmcnt(4)
    s_barrier
    v_mfma_f32_16x16x32_bf16 v[56:59], a[180:183], a[36:39], v[56:59]
    v_exp_f32 v42, v42
    v_mfma_f32_16x16x32_bf16 v[60:63], a[180:183], a[68:71], v[60:63]
    v_cvt_pk_bf16_f32 v100, v40, v41
    s_waitcnt lgkmcnt(4)
    v_mfma_f32_16x16x32_bf16 v[52:55], a[184:187], a[8:11], v[52:55]
    ds_read_b128 a[144:147], v3 offset:16896
    ds_read_b128 a[148:151], v3 offset:16960
    v_mfma_f32_16x16x32_bf16 v[56:59], a[184:187], a[40:43], v[56:59]
    v_exp_f32 v43, v43
    v_mfma_f32_16x16x32_bf16 v[60:63], a[184:187], a[72:75], v[60:63]
    v_exp_f32 v44, v44
    v_mfma_f32_16x16x32_bf16 v[52:55], a[188:191], a[12:15], v[52:55]
    buffer_load_dwordx4 v5, s[12:15], s30 offen offset:0 nt lds
    v_mfma_f32_16x16x32_bf16 v[56:59], a[188:191], a[44:47], v[56:59]
    v_exp_f32 v45, v45
    v_mfma_f32_16x16x32_bf16 v[60:63], a[188:191], a[76:79], v[60:63]
    v_cvt_pk_bf16_f32 v101, v42, v43
    s_waitcnt lgkmcnt(4)
    v_mfma_f32_16x16x32_bf16 v[52:55], a[192:195], a[16:19], v[52:55]
    ds_read_b128 a[152:155], v3 offset:17024
    ds_read_b128 a[156:159], v3 offset:17088
    v_mfma_f32_16x16x32_bf16 v[56:59], a[192:195], a[48:51], v[56:59]
    v_exp_f32 v46, v46
    v_mfma_f32_16x16x32_bf16 v[60:63], a[192:195], a[80:83], v[60:63]
    v_exp_f32 v47, v47
    v_mfma_f32_16x16x32_bf16 v[52:55], a[196:199], a[20:23], v[52:55]
    buffer_load_dwordx4 v6, s[12:15], s30 offen offset:1056 nt lds
    v_mfma_f32_16x16x32_bf16 v[56:59], a[196:199], a[52:55], v[56:59]
    v_exp_f32 v48, v48
    v_mfma_f32_16x16x32_bf16 v[60:63], a[196:199], a[84:87], v[60:63]
    v_cvt_pk_bf16_f32 v104, v44, v45
    s_waitcnt lgkmcnt(4)
    v_mfma_f32_16x16x32_bf16 v[52:55], a[200:203], a[24:27], v[52:55]
    ds_read_b128 a[160:163], v3 offset:17152
    ds_read_b128 a[164:167], v3 offset:17216
    v_mfma_f32_16x16x32_bf16 v[56:59], a[200:203], a[56:59], v[56:59]
    v_exp_f32 v49, v49
    v_mfma_f32_16x16x32_bf16 v[60:63], a[200:203], a[88:91], v[60:63]
    v_exp_f32 v50, v50
    v_mfma_f32_16x16x32_bf16 v[52:55], a[204:207], a[28:31], v[52:55]
    v_cvt_pk_bf16_f32 v105, v46, v47
    v_cvt_pk_bf16_f32 v108, v48, v49
    v_mfma_f32_16x16x32_bf16 v[56:59], a[204:207], a[60:63], v[56:59]
    v_exp_f32 v51, v51
    v_mfma_f32_16x16x32_bf16 v[60:63], a[204:207], a[92:95], v[60:63]
    v_cvt_pk_bf16_f32 v109, v50, v51
    s_waitcnt lgkmcnt(4)
    v_mfma_f32_16x16x32_bf16 v[40:43], a[144:147], a[0:3], v[28:31]
    ds_read_b128 a[168:171], v3 offset:17280
    ds_read_b128 a[172:175], v3 offset:17344
    v_mfma_f32_16x16x32_bf16 v[44:47], a[144:147], a[32:35], v[32:35]
    v_exp_f32 v52, v52
    v_mfma_f32_16x16x32_bf16 v[48:51], a[144:147], a[64:67], v[36:39]
    v_exp_f32 v53, v53
    v_mfma_f32_16x16x32_bf16 v[40:43], a[148:151], a[4:7], v[40:43]
    buffer_load_dwordx4 v7, s[12:15], s30 offen offset:2112 nt lds
    v_mfma_f32_16x16x32_bf16 v[44:47], a[148:151], a[36:39], v[44:47]
    v_exp_f32 v54, v54
    v_mfma_f32_16x16x32_bf16 v[48:51], a[148:151], a[68:71], v[48:51]
    v_cvt_pk_bf16_f32 v102, v52, v53
    s_waitcnt lgkmcnt(4)
    v_mfma_f32_16x16x32_bf16 v[40:43], a[152:155], a[8:11], v[40:43]
    ds_read_b128 a[176:179], v3 offset:25344
    ds_read_b128 a[180:183], v3 offset:25408
    v_mfma_f32_16x16x32_bf16 v[44:47], a[152:155], a[40:43], v[44:47]
    v_exp_f32 v55, v55
    v_mfma_f32_16x16x32_bf16 v[48:51], a[152:155], a[72:75], v[48:51]
    v_exp_f32 v56, v56
    v_mfma_f32_16x16x32_bf16 v[40:43], a[156:159], a[12:15], v[40:43]
    v_cvt_pk_bf16_f32 v103, v54, v55
    v_mfma_f32_16x16x32_bf16 v[44:47], a[156:159], a[44:47], v[44:47]
    v_exp_f32 v57, v57
    v_mfma_f32_16x16x32_bf16 v[48:51], a[156:159], a[76:79], v[48:51]
    v_cvt_pk_bf16_f32 v106, v56, v57
    s_waitcnt lgkmcnt(4)
    v_mfma_f32_16x16x32_bf16 v[40:43], a[160:163], a[16:19], v[40:43]
    ds_read_b128 a[184:187], v3 offset:25472
    ds_read_b128 a[188:191], v3 offset:25536
    v_mfma_f32_16x16x32_bf16 v[44:47], a[160:163], a[48:51], v[44:47]
    v_exp_f32 v58, v58
    v_mfma_f32_16x16x32_bf16 v[48:51], a[160:163], a[80:83], v[48:51]
    v_exp_f32 v59, v59
    v_mfma_f32_16x16x32_bf16 v[40:43], a[164:167], a[20:23], v[40:43]
    buffer_load_dwordx4 v8, s[12:15], s30 offen offset:3168 nt lds
    v_mfma_f32_16x16x32_bf16 v[44:47], a[164:167], a[52:55], v[44:47]
    v_exp_f32 v60, v60
    v_mfma_f32_16x16x32_bf16 v[48:51], a[164:167], a[84:87], v[48:51]
    v_cvt_pk_bf16_f32 v107, v58, v59
    s_waitcnt lgkmcnt(4)
    v_mfma_f32_16x16x32_bf16 v[40:43], a[168:171], a[24:27], v[40:43]
    ds_read_b128 a[192:195], v3 offset:25600
    ds_read_b128 a[196:199], v3 offset:25664
    v_mfma_f32_16x16x32_bf16 v[44:47], a[168:171], a[56:59], v[44:47]
    v_exp_f32 v61, v61
    v_mfma_f32_16x16x32_bf16 v[48:51], a[168:171], a[88:91], v[48:51]
    v_exp_f32 v62, v62
    v_mfma_f32_16x16x32_bf16 v[40:43], a[172:175], a[28:31], v[40:43]
    v_cvt_pk_bf16_f32 v110, v60, v61
    v_mfma_f32_16x16x32_bf16 v[44:47], a[172:175], a[60:63], v[44:47]
    v_exp_f32 v63, v63
    v_mfma_f32_16x16x32_bf16 v[48:51], a[172:175], a[92:95], v[48:51]
    v_cvt_pk_bf16_f32 v111, v62, v63
    s_waitcnt lgkmcnt(4)
    v_mfma_f32_16x16x32_bf16 a[128:131], a[140:143], v[100:103], a[128:131]
    s_add_u32 m0, s28, 118272
    s_mov_b32 s30, 114688
    v_mfma_f32_16x16x32_bf16 a[132:135], a[140:143], v[104:107], a[132:135]
    v_mfma_f32_16x16x32_bf16 a[136:139], a[140:143], v[108:111], a[136:139]
    v_mfma_f32_16x16x32_bf16 v[52:55], a[176:179], a[0:3], v[28:31]
    ds_read_b128 a[200:203], v3 offset:25728
    ds_read_b128 a[204:207], v3 offset:25792
    v_mfma_f32_16x16x32_bf16 v[56:59], a[176:179], a[32:35], v[32:35]
    v_exp_f32 v40, v40
    v_mfma_f32_16x16x32_bf16 v[60:63], a[176:179], a[64:67], v[36:39]
    v_exp_f32 v41, v41
    v_mfma_f32_16x16x32_bf16 v[52:55], a[180:183], a[4:7], v[52:55]
    s_waitcnt vmcnt(4)
    s_barrier
    v_mfma_f32_16x16x32_bf16 v[56:59], a[180:183], a[36:39], v[56:59]
    v_exp_f32 v42, v42
    v_mfma_f32_16x16x32_bf16 v[60:63], a[180:183], a[68:71], v[60:63]
    v_cvt_pk_bf16_f32 v112, v40, v41
    s_waitcnt lgkmcnt(4)
    v_mfma_f32_16x16x32_bf16 v[52:55], a[184:187], a[8:11], v[52:55]
    ds_read_b128 a[144:147], v3 offset:33792
    ds_read_b128 a[148:151], v3 offset:33856
    v_mfma_f32_16x16x32_bf16 v[56:59], a[184:187], a[40:43], v[56:59]
    v_exp_f32 v43, v43
    v_mfma_f32_16x16x32_bf16 v[60:63], a[184:187], a[72:75], v[60:63]
    v_exp_f32 v44, v44
    v_mfma_f32_16x16x32_bf16 v[52:55], a[188:191], a[12:15], v[52:55]
    buffer_load_dwordx4 v5, s[12:15], s30 offen offset:0 nt lds
    v_mfma_f32_16x16x32_bf16 v[56:59], a[188:191], a[44:47], v[56:59]
    v_exp_f32 v45, v45
    v_mfma_f32_16x16x32_bf16 v[60:63], a[188:191], a[76:79], v[60:63]
    v_cvt_pk_bf16_f32 v113, v42, v43
    s_waitcnt lgkmcnt(4)
    v_mfma_f32_16x16x32_bf16 v[52:55], a[192:195], a[16:19], v[52:55]
    ds_read_b128 a[152:155], v3 offset:33920
    ds_read_b128 a[156:159], v3 offset:33984
    v_mfma_f32_16x16x32_bf16 v[56:59], a[192:195], a[48:51], v[56:59]
    v_exp_f32 v46, v46
    v_mfma_f32_16x16x32_bf16 v[60:63], a[192:195], a[80:83], v[60:63]
    v_exp_f32 v47, v47
    v_mfma_f32_16x16x32_bf16 v[52:55], a[196:199], a[20:23], v[52:55]
    buffer_load_dwordx4 v6, s[12:15], s30 offen offset:1056 nt lds
    v_mfma_f32_16x16x32_bf16 v[56:59], a[196:199], a[52:55], v[56:59]
    v_exp_f32 v48, v48
    v_mfma_f32_16x16x32_bf16 v[60:63], a[196:199], a[84:87], v[60:63]
    v_cvt_pk_bf16_f32 v116, v44, v45
    s_waitcnt lgkmcnt(4)
    v_mfma_f32_16x16x32_bf16 v[52:55], a[200:203], a[24:27], v[52:55]
    ds_read_b128 a[160:163], v3 offset:34048
    ds_read_b128 a[164:167], v3 offset:34112
    v_mfma_f32_16x16x32_bf16 v[56:59], a[200:203], a[56:59], v[56:59]
    v_exp_f32 v49, v49
    v_mfma_f32_16x16x32_bf16 v[60:63], a[200:203], a[88:91], v[60:63]
    v_exp_f32 v50, v50
    v_mfma_f32_16x16x32_bf16 v[52:55], a[204:207], a[28:31], v[52:55]
    v_cvt_pk_bf16_f32 v117, v46, v47
    v_cvt_pk_bf16_f32 v120, v48, v49
    v_mfma_f32_16x16x32_bf16 v[56:59], a[204:207], a[60:63], v[56:59]
    v_exp_f32 v51, v51
    v_mfma_f32_16x16x32_bf16 v[60:63], a[204:207], a[92:95], v[60:63]
    v_cvt_pk_bf16_f32 v121, v50, v51
    s_waitcnt lgkmcnt(4)
    v_mfma_f32_16x16x32_bf16 v[40:43], a[144:147], a[0:3], v[28:31]
    ds_read_b128 a[168:171], v3 offset:34176
    ds_read_b128 a[172:175], v3 offset:34240
    v_mfma_f32_16x16x32_bf16 v[44:47], a[144:147], a[32:35], v[32:35]
    v_exp_f32 v52, v52
    v_mfma_f32_16x16x32_bf16 v[48:51], a[144:147], a[64:67], v[36:39]
    v_exp_f32 v53, v53
    v_mfma_f32_16x16x32_bf16 v[40:43], a[148:151], a[4:7], v[40:43]
    buffer_load_dwordx4 v7, s[12:15], s30 offen offset:2112 nt lds
    v_mfma_f32_16x16x32_bf16 v[44:47], a[148:151], a[36:39], v[44:47]
    v_exp_f32 v54, v54
    v_mfma_f32_16x16x32_bf16 v[48:51], a[148:151], a[68:71], v[48:51]
    v_cvt_pk_bf16_f32 v114, v52, v53
    s_waitcnt lgkmcnt(4)
    v_mfma_f32_16x16x32_bf16 v[40:43], a[152:155], a[8:11], v[40:43]
    ds_read_b128 a[176:179], v3 offset:42240
    ds_read_b128 a[180:183], v3 offset:42304
    v_mfma_f32_16x16x32_bf16 v[44:47], a[152:155], a[40:43], v[44:47]
    v_exp_f32 v55, v55
    v_mfma_f32_16x16x32_bf16 v[48:51], a[152:155], a[72:75], v[48:51]
    v_exp_f32 v56, v56
    v_mfma_f32_16x16x32_bf16 v[40:43], a[156:159], a[12:15], v[40:43]
    v_cvt_pk_bf16_f32 v115, v54, v55
    v_mfma_f32_16x16x32_bf16 v[44:47], a[156:159], a[44:47], v[44:47]
    v_exp_f32 v57, v57
    v_mfma_f32_16x16x32_bf16 v[48:51], a[156:159], a[76:79], v[48:51]
    v_cvt_pk_bf16_f32 v118, v56, v57
    s_waitcnt lgkmcnt(4)
    v_mfma_f32_16x16x32_bf16 v[40:43], a[160:163], a[16:19], v[40:43]
    ds_read_b128 a[184:187], v3 offset:42368
    ds_read_b128 a[188:191], v3 offset:42432
    v_mfma_f32_16x16x32_bf16 v[44:47], a[160:163], a[48:51], v[44:47]
    v_exp_f32 v58, v58
    v_mfma_f32_16x16x32_bf16 v[48:51], a[160:163], a[80:83], v[48:51]
    v_exp_f32 v59, v59
    v_mfma_f32_16x16x32_bf16 v[40:43], a[164:167], a[20:23], v[40:43]
    buffer_load_dwordx4 v8, s[12:15], s30 offen offset:3168 nt lds
    v_mfma_f32_16x16x32_bf16 v[44:47], a[164:167], a[52:55], v[44:47]
    v_exp_f32 v60, v60
    v_mfma_f32_16x16x32_bf16 v[48:51], a[164:167], a[84:87], v[48:51]
    v_cvt_pk_bf16_f32 v119, v58, v59
    s_waitcnt lgkmcnt(4)
    v_mfma_f32_16x16x32_bf16 v[40:43], a[168:171], a[24:27], v[40:43]
    ds_read_b128 a[192:195], v3 offset:42496
    ds_read_b128 a[196:199], v3 offset:42560
    v_mfma_f32_16x16x32_bf16 v[44:47], a[168:171], a[56:59], v[44:47]
    v_exp_f32 v61, v61
    v_mfma_f32_16x16x32_bf16 v[48:51], a[168:171], a[88:91], v[48:51]
    v_exp_f32 v62, v62
    v_mfma_f32_16x16x32_bf16 v[40:43], a[172:175], a[28:31], v[40:43]
    v_cvt_pk_bf16_f32 v122, v60, v61
    v_mfma_f32_16x16x32_bf16 v[44:47], a[172:175], a[60:63], v[44:47]
    v_exp_f32 v63, v63
    v_mfma_f32_16x16x32_bf16 v[48:51], a[172:175], a[92:95], v[48:51]
    v_cvt_pk_bf16_f32 v123, v62, v63
    s_waitcnt lgkmcnt(4)
    v_mfma_f32_16x16x32_bf16 a[128:131], a[140:143], v[112:115], a[128:131]
    s_add_u32 m0, s28, 135168
    s_mov_b32 s30, 131072
    v_mfma_f32_16x16x32_bf16 a[132:135], a[140:143], v[116:119], a[132:135]
    v_mfma_f32_16x16x32_bf16 a[136:139], a[140:143], v[120:123], a[136:139]
    v_mfma_f32_16x16x32_bf16 v[52:55], a[176:179], a[0:3], v[28:31]
    ds_read_b128 a[200:203], v3 offset:42624
    ds_read_b128 a[204:207], v3 offset:42688
    v_mfma_f32_16x16x32_bf16 v[56:59], a[176:179], a[32:35], v[32:35]
    v_exp_f32 v40, v40
    v_mfma_f32_16x16x32_bf16 v[60:63], a[176:179], a[64:67], v[36:39]
    v_exp_f32 v41, v41
    v_mfma_f32_16x16x32_bf16 v[52:55], a[180:183], a[4:7], v[52:55]
    s_waitcnt vmcnt(4)
    s_barrier
    v_mfma_f32_16x16x32_bf16 v[56:59], a[180:183], a[36:39], v[56:59]
    v_exp_f32 v42, v42
    v_mfma_f32_16x16x32_bf16 v[60:63], a[180:183], a[68:71], v[60:63]
    v_cvt_pk_bf16_f32 v124, v40, v41
    s_waitcnt lgkmcnt(4)
    v_mfma_f32_16x16x32_bf16 v[52:55], a[184:187], a[8:11], v[52:55]
    ds_read_b128 a[144:147], v4 offset:0
    ds_read_b128 a[148:151], v4 offset:64
    v_mfma_f32_16x16x32_bf16 v[56:59], a[184:187], a[40:43], v[56:59]
    buffer_load_dwordx4 v5, s[12:15], s30 offen offset:0 nt lds
    v_exp_f32 v43, v43
    v_mfma_f32_16x16x32_bf16 v[60:63], a[184:187], a[72:75], v[60:63]
    v_exp_f32 v44, v44
    v_mfma_f32_16x16x32_bf16 v[52:55], a[188:191], a[12:15], v[52:55]
    buffer_load_dwordx4 v6, s[12:15], s30 offen offset:1056 nt lds
    v_mfma_f32_16x16x32_bf16 v[56:59], a[188:191], a[44:47], v[56:59]
    v_exp_f32 v45, v45
    v_mfma_f32_16x16x32_bf16 v[60:63], a[188:191], a[76:79], v[60:63]
    v_cvt_pk_bf16_f32 v125, v42, v43
    s_waitcnt lgkmcnt(4)
    v_mfma_f32_16x16x32_bf16 v[52:55], a[192:195], a[16:19], v[52:55]
    ds_read_b128 a[152:155], v4 offset:128
    ds_read_b128 a[156:159], v4 offset:192
    v_mfma_f32_16x16x32_bf16 v[56:59], a[192:195], a[48:51], v[56:59]
    buffer_load_dwordx4 v7, s[12:15], s30 offen offset:2112 nt lds
    v_exp_f32 v46, v46
    v_mfma_f32_16x16x32_bf16 v[60:63], a[192:195], a[80:83], v[60:63]
    v_exp_f32 v47, v47
    v_mfma_f32_16x16x32_bf16 v[52:55], a[196:199], a[20:23], v[52:55]
    buffer_load_dwordx4 v8, s[12:15], s30 offen offset:3168 nt lds
    v_mfma_f32_16x16x32_bf16 v[56:59], a[196:199], a[52:55], v[56:59]
    v_exp_f32 v48, v48
    v_mfma_f32_16x16x32_bf16 v[60:63], a[196:199], a[84:87], v[60:63]
    v_cvt_pk_bf16_f32 v128, v44, v45
    s_waitcnt lgkmcnt(4)
    v_mfma_f32_16x16x32_bf16 v[52:55], a[200:203], a[24:27], v[52:55]
    ds_read_b128 a[160:163], v4 offset:256
    ds_read_b128 a[164:167], v4 offset:320
    v_mfma_f32_16x16x32_bf16 v[56:59], a[200:203], a[56:59], v[56:59]
    s_add_u32 m0, s28, 0
    s_mov_b32 s30, 147456
    v_exp_f32 v49, v49
    v_mfma_f32_16x16x32_bf16 v[60:63], a[200:203], a[88:91], v[60:63]
    v_exp_f32 v50, v50
    v_mfma_f32_16x16x32_bf16 v[52:55], a[204:207], a[28:31], v[52:55]
    v_cvt_pk_bf16_f32 v129, v46, v47
    v_cvt_pk_bf16_f32 v132, v48, v49
    v_mfma_f32_16x16x32_bf16 v[56:59], a[204:207], a[60:63], v[56:59]
    buffer_load_dwordx4 v5, s[12:15], s30 offen offset:0 nt lds
    v_exp_f32 v51, v51
    v_mfma_f32_16x16x32_bf16 v[60:63], a[204:207], a[92:95], v[60:63]
    v_cvt_pk_bf16_f32 v133, v50, v51
    s_waitcnt lgkmcnt(4)
    v_mfma_f32_16x16x32_bf16 v[40:43], a[144:147], a[0:3], v[28:31]
    ds_read_b128 a[168:171], v4 offset:384
    ds_read_b128 a[172:175], v4 offset:448
    v_mfma_f32_16x16x32_bf16 v[44:47], a[144:147], a[32:35], v[32:35]
    v_exp_f32 v52, v52
    v_mfma_f32_16x16x32_bf16 v[48:51], a[144:147], a[64:67], v[36:39]
    v_exp_f32 v53, v53
    v_mfma_f32_16x16x32_bf16 v[40:43], a[148:151], a[4:7], v[40:43]
    buffer_load_dwordx4 v6, s[12:15], s30 offen offset:1056 nt lds
    v_mfma_f32_16x16x32_bf16 v[44:47], a[148:151], a[36:39], v[44:47]
    v_exp_f32 v54, v54
    v_mfma_f32_16x16x32_bf16 v[48:51], a[148:151], a[68:71], v[48:51]
    v_cvt_pk_bf16_f32 v126, v52, v53
    s_waitcnt lgkmcnt(4)
    v_mfma_f32_16x16x32_bf16 v[40:43], a[152:155], a[8:11], v[40:43]
    ds_read_b128 a[176:179], v4 offset:8448
    ds_read_b128 a[180:183], v4 offset:8512
    v_mfma_f32_16x16x32_bf16 v[44:47], a[152:155], a[40:43], v[44:47]
    buffer_load_dwordx4 v7, s[12:15], s30 offen offset:2112 nt lds
    v_exp_f32 v55, v55
    v_mfma_f32_16x16x32_bf16 v[48:51], a[152:155], a[72:75], v[48:51]
    v_exp_f32 v56, v56
    v_mfma_f32_16x16x32_bf16 v[40:43], a[156:159], a[12:15], v[40:43]
    v_cvt_pk_bf16_f32 v127, v54, v55
    v_mfma_f32_16x16x32_bf16 v[44:47], a[156:159], a[44:47], v[44:47]
    v_exp_f32 v57, v57
    v_mfma_f32_16x16x32_bf16 v[48:51], a[156:159], a[76:79], v[48:51]
    v_cvt_pk_bf16_f32 v130, v56, v57
    s_waitcnt lgkmcnt(4)
    v_mfma_f32_16x16x32_bf16 v[40:43], a[160:163], a[16:19], v[40:43]
    ds_read_b128 a[184:187], v4 offset:8576
    ds_read_b128 a[188:191], v4 offset:8640
    v_mfma_f32_16x16x32_bf16 v[44:47], a[160:163], a[48:51], v[44:47]
    v_exp_f32 v58, v58
    v_mfma_f32_16x16x32_bf16 v[48:51], a[160:163], a[80:83], v[48:51]
    v_exp_f32 v59, v59
    v_mfma_f32_16x16x32_bf16 v[40:43], a[164:167], a[20:23], v[40:43]
    buffer_load_dwordx4 v8, s[12:15], s30 offen offset:3168 nt lds
    v_mfma_f32_16x16x32_bf16 v[44:47], a[164:167], a[52:55], v[44:47]
    v_exp_f32 v60, v60
    v_mfma_f32_16x16x32_bf16 v[48:51], a[164:167], a[84:87], v[48:51]
    v_cvt_pk_bf16_f32 v131, v58, v59
    s_waitcnt lgkmcnt(4)
    v_mfma_f32_16x16x32_bf16 v[40:43], a[168:171], a[24:27], v[40:43]
    ds_read_b128 a[192:195], v4 offset:8704
    ds_read_b128 a[196:199], v4 offset:8768
    v_mfma_f32_16x16x32_bf16 v[44:47], a[168:171], a[56:59], v[44:47]
    v_exp_f32 v61, v61
    v_mfma_f32_16x16x32_bf16 v[48:51], a[168:171], a[88:91], v[48:51]
    v_exp_f32 v62, v62
    v_mfma_f32_16x16x32_bf16 v[40:43], a[172:175], a[28:31], v[40:43]
    v_cvt_pk_bf16_f32 v134, v60, v61
    v_mfma_f32_16x16x32_bf16 v[44:47], a[172:175], a[60:63], v[44:47]
    v_exp_f32 v63, v63
    v_mfma_f32_16x16x32_bf16 v[48:51], a[172:175], a[92:95], v[48:51]
    v_cvt_pk_bf16_f32 v135, v62, v63
    s_waitcnt lgkmcnt(4)
    v_mfma_f32_16x16x32_bf16 a[128:131], a[140:143], v[124:127], a[128:131]
    s_add_u32 m0, s28, 16896
    s_mov_b32 s30, 163840
    v_mfma_f32_16x16x32_bf16 a[132:135], a[140:143], v[128:131], a[132:135]
    v_mfma_f32_16x16x32_bf16 a[136:139], a[140:143], v[132:135], a[136:139]
    v_mfma_f32_16x16x32_bf16 v[52:55], a[176:179], a[0:3], v[28:31]
    ds_read_b128 a[200:203], v4 offset:8832
    ds_read_b128 a[204:207], v4 offset:8896
    v_mfma_f32_16x16x32_bf16 v[56:59], a[176:179], a[32:35], v[32:35]
    v_exp_f32 v40, v40
    v_mfma_f32_16x16x32_bf16 v[60:63], a[176:179], a[64:67], v[36:39]
    v_exp_f32 v41, v41
    v_mfma_f32_16x16x32_bf16 v[52:55], a[180:183], a[4:7], v[52:55]
    s_waitcnt vmcnt(8)
    s_barrier
    v_mfma_f32_16x16x32_bf16 v[56:59], a[180:183], a[36:39], v[56:59]
    v_exp_f32 v42, v42
    v_mfma_f32_16x16x32_bf16 v[60:63], a[180:183], a[68:71], v[60:63]
    v_cvt_pk_bf16_f32 v136, v40, v41
    s_waitcnt lgkmcnt(4)
    v_mfma_f32_16x16x32_bf16 v[52:55], a[184:187], a[8:11], v[52:55]
    ds_read_b128 a[144:147], v4 offset:16896
    ds_read_b128 a[148:151], v4 offset:16960
    v_mfma_f32_16x16x32_bf16 v[56:59], a[184:187], a[40:43], v[56:59]
    v_exp_f32 v43, v43
    v_mfma_f32_16x16x32_bf16 v[60:63], a[184:187], a[72:75], v[60:63]
    v_exp_f32 v44, v44
    v_mfma_f32_16x16x32_bf16 v[52:55], a[188:191], a[12:15], v[52:55]
    buffer_load_dwordx4 v5, s[12:15], s30 offen offset:0 nt lds
    v_mfma_f32_16x16x32_bf16 v[56:59], a[188:191], a[44:47], v[56:59]
    v_exp_f32 v45, v45
    v_mfma_f32_16x16x32_bf16 v[60:63], a[188:191], a[76:79], v[60:63]
    v_cvt_pk_bf16_f32 v137, v42, v43
    s_waitcnt lgkmcnt(4)
    v_mfma_f32_16x16x32_bf16 v[52:55], a[192:195], a[16:19], v[52:55]
    ds_read_b128 a[152:155], v4 offset:17024
    ds_read_b128 a[156:159], v4 offset:17088
    v_mfma_f32_16x16x32_bf16 v[56:59], a[192:195], a[48:51], v[56:59]
    v_exp_f32 v46, v46
    v_mfma_f32_16x16x32_bf16 v[60:63], a[192:195], a[80:83], v[60:63]
    v_exp_f32 v47, v47
    v_mfma_f32_16x16x32_bf16 v[52:55], a[196:199], a[20:23], v[52:55]
    buffer_load_dwordx4 v6, s[12:15], s30 offen offset:1056 nt lds
    v_mfma_f32_16x16x32_bf16 v[56:59], a[196:199], a[52:55], v[56:59]
    v_exp_f32 v48, v48
    v_mfma_f32_16x16x32_bf16 v[60:63], a[196:199], a[84:87], v[60:63]
    v_cvt_pk_bf16_f32 v140, v44, v45
    s_waitcnt lgkmcnt(4)
    v_mfma_f32_16x16x32_bf16 v[52:55], a[200:203], a[24:27], v[52:55]
    ds_read_b128 a[160:163], v4 offset:17152
    ds_read_b128 a[164:167], v4 offset:17216
    v_mfma_f32_16x16x32_bf16 v[56:59], a[200:203], a[56:59], v[56:59]
    v_exp_f32 v49, v49
    v_mfma_f32_16x16x32_bf16 v[60:63], a[200:203], a[88:91], v[60:63]
    v_exp_f32 v50, v50
    v_mfma_f32_16x16x32_bf16 v[52:55], a[204:207], a[28:31], v[52:55]
    v_cvt_pk_bf16_f32 v141, v46, v47
    v_cvt_pk_bf16_f32 v144, v48, v49
    v_mfma_f32_16x16x32_bf16 v[56:59], a[204:207], a[60:63], v[56:59]
    v_exp_f32 v51, v51
    v_mfma_f32_16x16x32_bf16 v[60:63], a[204:207], a[92:95], v[60:63]
    v_cvt_pk_bf16_f32 v145, v50, v51
    s_waitcnt lgkmcnt(4)
    v_mfma_f32_16x16x32_bf16 v[40:43], a[144:147], a[0:3], v[28:31]
    ds_read_b128 a[168:171], v4 offset:17280
    ds_read_b128 a[172:175], v4 offset:17344
    v_mfma_f32_16x16x32_bf16 v[44:47], a[144:147], a[32:35], v[32:35]
    v_exp_f32 v52, v52
    v_mfma_f32_16x16x32_bf16 v[48:51], a[144:147], a[64:67], v[36:39]
    v_exp_f32 v53, v53
    v_mfma_f32_16x16x32_bf16 v[40:43], a[148:151], a[4:7], v[40:43]
    buffer_load_dwordx4 v7, s[12:15], s30 offen offset:2112 nt lds
    v_mfma_f32_16x16x32_bf16 v[44:47], a[148:151], a[36:39], v[44:47]
    v_exp_f32 v54, v54
    v_mfma_f32_16x16x32_bf16 v[48:51], a[148:151], a[68:71], v[48:51]
    v_cvt_pk_bf16_f32 v138, v52, v53
    s_waitcnt lgkmcnt(4)
    v_mfma_f32_16x16x32_bf16 v[40:43], a[152:155], a[8:11], v[40:43]
    ds_read_b128 a[176:179], v4 offset:25344
    ds_read_b128 a[180:183], v4 offset:25408
    v_mfma_f32_16x16x32_bf16 v[44:47], a[152:155], a[40:43], v[44:47]
    v_exp_f32 v55, v55
    v_mfma_f32_16x16x32_bf16 v[48:51], a[152:155], a[72:75], v[48:51]
    v_exp_f32 v56, v56
    v_mfma_f32_16x16x32_bf16 v[40:43], a[156:159], a[12:15], v[40:43]
    v_cvt_pk_bf16_f32 v139, v54, v55
    v_mfma_f32_16x16x32_bf16 v[44:47], a[156:159], a[44:47], v[44:47]
    v_exp_f32 v57, v57
    v_mfma_f32_16x16x32_bf16 v[48:51], a[156:159], a[76:79], v[48:51]
    v_cvt_pk_bf16_f32 v142, v56, v57
    s_waitcnt lgkmcnt(4)
    v_mfma_f32_16x16x32_bf16 v[40:43], a[160:163], a[16:19], v[40:43]
    ds_read_b128 a[184:187], v4 offset:25472
    ds_read_b128 a[188:191], v4 offset:25536
    v_mfma_f32_16x16x32_bf16 v[44:47], a[160:163], a[48:51], v[44:47]
    v_exp_f32 v58, v58
    v_mfma_f32_16x16x32_bf16 v[48:51], a[160:163], a[80:83], v[48:51]
    v_exp_f32 v59, v59
    v_mfma_f32_16x16x32_bf16 v[40:43], a[164:167], a[20:23], v[40:43]
    buffer_load_dwordx4 v8, s[12:15], s30 offen offset:3168 nt lds
    v_mfma_f32_16x16x32_bf16 v[44:47], a[164:167], a[52:55], v[44:47]
    v_exp_f32 v60, v60
    v_mfma_f32_16x16x32_bf16 v[48:51], a[164:167], a[84:87], v[48:51]
    v_cvt_pk_bf16_f32 v143, v58, v59
    s_waitcnt lgkmcnt(4)
    v_mfma_f32_16x16x32_bf16 v[40:43], a[168:171], a[24:27], v[40:43]
    ds_read_b128 a[192:195], v4 offset:25600
    ds_read_b128 a[196:199], v4 offset:25664
    v_mfma_f32_16x16x32_bf16 v[44:47], a[168:171], a[56:59], v[44:47]
    v_exp_f32 v61, v61
    v_mfma_f32_16x16x32_bf16 v[48:51], a[168:171], a[88:91], v[48:51]
    v_exp_f32 v62, v62
    v_mfma_f32_16x16x32_bf16 v[40:43], a[172:175], a[28:31], v[40:43]
    v_cvt_pk_bf16_f32 v146, v60, v61
    v_mfma_f32_16x16x32_bf16 v[44:47], a[172:175], a[60:63], v[44:47]
    v_exp_f32 v63, v63
    v_mfma_f32_16x16x32_bf16 v[48:51], a[172:175], a[92:95], v[48:51]
    v_cvt_pk_bf16_f32 v147, v62, v63
    s_waitcnt lgkmcnt(4)
    v_mfma_f32_16x16x32_bf16 a[128:131], a[140:143], v[136:139], a[128:131]
    s_add_u32 m0, s28, 33792
    s_mov_b32 s30, 180224
    v_mfma_f32_16x16x32_bf16 a[132:135], a[140:143], v[140:143], a[132:135]
    v_mfma_f32_16x16x32_bf16 a[136:139], a[140:143], v[144:147], a[136:139]
    v_mfma_f32_16x16x32_bf16 v[52:55], a[176:179], a[0:3], v[28:31]
    ds_read_b128 a[200:203], v4 offset:25728
    ds_read_b128 a[204:207], v4 offset:25792
    v_mfma_f32_16x16x32_bf16 v[56:59], a[176:179], a[32:35], v[32:35]
    v_exp_f32 v40, v40
    v_mfma_f32_16x16x32_bf16 v[60:63], a[176:179], a[64:67], v[36:39]
    v_exp_f32 v41, v41
    v_mfma_f32_16x16x32_bf16 v[52:55], a[180:183], a[4:7], v[52:55]
    s_waitcnt vmcnt(8)
    s_barrier
    v_mfma_f32_16x16x32_bf16 v[56:59], a[180:183], a[36:39], v[56:59]
    v_exp_f32 v42, v42
    v_mfma_f32_16x16x32_bf16 v[60:63], a[180:183], a[68:71], v[60:63]
    v_cvt_pk_bf16_f32 v148, v40, v41
    s_waitcnt lgkmcnt(4)
    v_mfma_f32_16x16x32_bf16 v[52:55], a[184:187], a[8:11], v[52:55]
    ds_read_b128 a[144:147], v4 offset:33792
    ds_read_b128 a[148:151], v4 offset:33856
    v_mfma_f32_16x16x32_bf16 v[56:59], a[184:187], a[40:43], v[56:59]
    buffer_load_dwordx4 v5, s[12:15], s30 offen offset:0 nt lds
    v_exp_f32 v43, v43
    v_mfma_f32_16x16x32_bf16 v[60:63], a[184:187], a[72:75], v[60:63]
    v_exp_f32 v44, v44
    v_mfma_f32_16x16x32_bf16 v[52:55], a[188:191], a[12:15], v[52:55]
    buffer_load_dwordx4 v6, s[12:15], s30 offen offset:1056 nt lds
    v_mfma_f32_16x16x32_bf16 v[56:59], a[188:191], a[44:47], v[56:59]
    v_exp_f32 v45, v45
    v_mfma_f32_16x16x32_bf16 v[60:63], a[188:191], a[76:79], v[60:63]
    v_cvt_pk_bf16_f32 v149, v42, v43
    s_waitcnt lgkmcnt(4)
    v_mfma_f32_16x16x32_bf16 v[52:55], a[192:195], a[16:19], v[52:55]
    ds_read_b128 a[152:155], v4 offset:33920
    ds_read_b128 a[156:159], v4 offset:33984
    v_mfma_f32_16x16x32_bf16 v[56:59], a[192:195], a[48:51], v[56:59]
    buffer_load_dwordx4 v7, s[12:15], s30 offen offset:2112 nt lds
    v_exp_f32 v46, v46
    v_mfma_f32_16x16x32_bf16 v[60:63], a[192:195], a[80:83], v[60:63]
    v_exp_f32 v47, v47
    v_mfma_f32_16x16x32_bf16 v[52:55], a[196:199], a[20:23], v[52:55]
    buffer_load_dwordx4 v8, s[12:15], s30 offen offset:3168 nt lds
    v_mfma_f32_16x16x32_bf16 v[56:59], a[196:199], a[52:55], v[56:59]
    v_exp_f32 v48, v48
    v_mfma_f32_16x16x32_bf16 v[60:63], a[196:199], a[84:87], v[60:63]
    v_cvt_pk_bf16_f32 v152, v44, v45
    s_waitcnt lgkmcnt(4)
    v_mfma_f32_16x16x32_bf16 v[52:55], a[200:203], a[24:27], v[52:55]
    ds_read_b128 a[160:163], v4 offset:34048
    ds_read_b128 a[164:167], v4 offset:34112
    v_mfma_f32_16x16x32_bf16 v[56:59], a[200:203], a[56:59], v[56:59]
    s_add_u32 m0, s28, 50688
    s_mov_b32 s30, 196608
    v_exp_f32 v49, v49
    v_mfma_f32_16x16x32_bf16 v[60:63], a[200:203], a[88:91], v[60:63]
    v_exp_f32 v50, v50
    v_mfma_f32_16x16x32_bf16 v[52:55], a[204:207], a[28:31], v[52:55]
    v_cvt_pk_bf16_f32 v153, v46, v47
    v_cvt_pk_bf16_f32 v156, v48, v49
    v_mfma_f32_16x16x32_bf16 v[56:59], a[204:207], a[60:63], v[56:59]
    buffer_load_dwordx4 v5, s[12:15], s30 offen offset:0 nt lds
    v_exp_f32 v51, v51
    v_mfma_f32_16x16x32_bf16 v[60:63], a[204:207], a[92:95], v[60:63]
    v_cvt_pk_bf16_f32 v157, v50, v51
    s_waitcnt lgkmcnt(4)
    v_mfma_f32_16x16x32_bf16 v[40:43], a[144:147], a[0:3], v[28:31]
    ds_read_b128 a[168:171], v4 offset:34176
    ds_read_b128 a[172:175], v4 offset:34240
    v_mfma_f32_16x16x32_bf16 v[44:47], a[144:147], a[32:35], v[32:35]
    v_exp_f32 v52, v52
    v_mfma_f32_16x16x32_bf16 v[48:51], a[144:147], a[64:67], v[36:39]
    v_exp_f32 v53, v53
    v_mfma_f32_16x16x32_bf16 v[40:43], a[148:151], a[4:7], v[40:43]
    buffer_load_dwordx4 v6, s[12:15], s30 offen offset:1056 nt lds
    v_mfma_f32_16x16x32_bf16 v[44:47], a[148:151], a[36:39], v[44:47]
    v_exp_f32 v54, v54
    v_mfma_f32_16x16x32_bf16 v[48:51], a[148:151], a[68:71], v[48:51]
    v_cvt_pk_bf16_f32 v150, v52, v53
    s_waitcnt lgkmcnt(4)
    v_mfma_f32_16x16x32_bf16 v[40:43], a[152:155], a[8:11], v[40:43]
    ds_read_b128 a[176:179], v4 offset:42240
    ds_read_b128 a[180:183], v4 offset:42304
    v_mfma_f32_16x16x32_bf16 v[44:47], a[152:155], a[40:43], v[44:47]
    buffer_load_dwordx4 v7, s[12:15], s30 offen offset:2112 nt lds
    v_exp_f32 v55, v55
    v_mfma_f32_16x16x32_bf16 v[48:51], a[152:155], a[72:75], v[48:51]
    v_exp_f32 v56, v56
    v_mfma_f32_16x16x32_bf16 v[40:43], a[156:159], a[12:15], v[40:43]
    v_cvt_pk_bf16_f32 v151, v54, v55
    v_mfma_f32_16x16x32_bf16 v[44:47], a[156:159], a[44:47], v[44:47]
    v_exp_f32 v57, v57
    v_mfma_f32_16x16x32_bf16 v[48:51], a[156:159], a[76:79], v[48:51]
    v_cvt_pk_bf16_f32 v154, v56, v57
    s_waitcnt lgkmcnt(4)
    v_mfma_f32_16x16x32_bf16 v[40:43], a[160:163], a[16:19], v[40:43]
    ds_read_b128 a[184:187], v4 offset:42368
    ds_read_b128 a[188:191], v4 offset:42432
    v_mfma_f32_16x16x32_bf16 v[44:47], a[160:163], a[48:51], v[44:47]
    v_exp_f32 v58, v58
    v_mfma_f32_16x16x32_bf16 v[48:51], a[160:163], a[80:83], v[48:51]
    v_exp_f32 v59, v59
    v_mfma_f32_16x16x32_bf16 v[40:43], a[164:167], a[20:23], v[40:43]
    buffer_load_dwordx4 v8, s[12:15], s30 offen offset:3168 nt lds
    v_mfma_f32_16x16x32_bf16 v[44:47], a[164:167], a[52:55], v[44:47]
    v_exp_f32 v60, v60
    v_mfma_f32_16x16x32_bf16 v[48:51], a[164:167], a[84:87], v[48:51]
    v_cvt_pk_bf16_f32 v155, v58, v59
    s_waitcnt lgkmcnt(4)
    v_mfma_f32_16x16x32_bf16 v[40:43], a[168:171], a[24:27], v[40:43]
    ds_read_b128 a[192:195], v4 offset:42496
    ds_read_b128 a[196:199], v4 offset:42560
    v_mfma_f32_16x16x32_bf16 v[44:47], a[168:171], a[56:59], v[44:47]
    v_exp_f32 v61, v61
    v_mfma_f32_16x16x32_bf16 v[48:51], a[168:171], a[88:91], v[48:51]
    v_exp_f32 v62, v62
    v_mfma_f32_16x16x32_bf16 v[40:43], a[172:175], a[28:31], v[40:43]
    v_cvt_pk_bf16_f32 v158, v60, v61
    v_mfma_f32_16x16x32_bf16 v[44:47], a[172:175], a[60:63], v[44:47]
    v_exp_f32 v63, v63
    v_mfma_f32_16x16x32_bf16 v[48:51], a[172:175], a[92:95], v[48:51]
    v_cvt_pk_bf16_f32 v159, v62, v63
    s_waitcnt lgkmcnt(4)
    v_mfma_f32_16x16x32_bf16 a[128:131], a[140:143], v[148:151], a[128:131]
    s_add_u32 m0, s28, 67584
    s_mov_b32 s30, 212992
    v_mfma_f32_16x16x32_bf16 a[132:135], a[140:143], v[152:155], a[132:135]
    v_mfma_f32_16x16x32_bf16 a[136:139], a[140:143], v[156:159], a[136:139]
    v_mfma_f32_16x16x32_bf16 v[52:55], a[176:179], a[0:3], v[28:31]
    ds_read_b128 a[200:203], v4 offset:42624
    ds_read_b128 a[204:207], v4 offset:42688
    v_mfma_f32_16x16x32_bf16 v[56:59], a[176:179], a[32:35], v[32:35]
    v_exp_f32 v40, v40
    v_mfma_f32_16x16x32_bf16 v[60:63], a[176:179], a[64:67], v[36:39]
    v_exp_f32 v41, v41
    v_mfma_f32_16x16x32_bf16 v[52:55], a[180:183], a[4:7], v[52:55]
    s_waitcnt vmcnt(12)
    s_barrier
    v_mfma_f32_16x16x32_bf16 v[56:59], a[180:183], a[36:39], v[56:59]
    v_exp_f32 v42, v42
    v_mfma_f32_16x16x32_bf16 v[60:63], a[180:183], a[68:71], v[60:63]
    v_cvt_pk_bf16_f32 v160, v40, v41
    s_waitcnt lgkmcnt(4)
    v_mfma_f32_16x16x32_bf16 v[52:55], a[184:187], a[8:11], v[52:55]
    ds_read_b128 a[144:147], v2 offset:0
    ds_read_b128 a[148:151], v2 offset:64
    v_mfma_f32_16x16x32_bf16 v[56:59], a[184:187], a[40:43], v[56:59]
    v_exp_f32 v43, v43
    v_mfma_f32_16x16x32_bf16 v[60:63], a[184:187], a[72:75], v[60:63]
    v_exp_f32 v44, v44
    v_mfma_f32_16x16x32_bf16 v[52:55], a[188:191], a[12:15], v[52:55]
    buffer_load_dwordx4 v5, s[12:15], s30 offen offset:0 nt lds
    v_mfma_f32_16x16x32_bf16 v[56:59], a[188:191], a[44:47], v[56:59]
    v_exp_f32 v45, v45
    v_mfma_f32_16x16x32_bf16 v[60:63], a[188:191], a[76:79], v[60:63]
    v_cvt_pk_bf16_f32 v161, v42, v43
    s_waitcnt lgkmcnt(4)
    v_mfma_f32_16x16x32_bf16 v[52:55], a[192:195], a[16:19], v[52:55]
    ds_read_b128 a[152:155], v2 offset:128
    ds_read_b128 a[156:159], v2 offset:192
    v_mfma_f32_16x16x32_bf16 v[56:59], a[192:195], a[48:51], v[56:59]
    v_exp_f32 v46, v46
    v_mfma_f32_16x16x32_bf16 v[60:63], a[192:195], a[80:83], v[60:63]
    v_exp_f32 v47, v47
    v_mfma_f32_16x16x32_bf16 v[52:55], a[196:199], a[20:23], v[52:55]
    buffer_load_dwordx4 v6, s[12:15], s30 offen offset:1056 nt lds
    v_mfma_f32_16x16x32_bf16 v[56:59], a[196:199], a[52:55], v[56:59]
    v_exp_f32 v48, v48
    v_mfma_f32_16x16x32_bf16 v[60:63], a[196:199], a[84:87], v[60:63]
    v_cvt_pk_bf16_f32 v164, v44, v45
    s_waitcnt lgkmcnt(4)
    v_mfma_f32_16x16x32_bf16 v[52:55], a[200:203], a[24:27], v[52:55]
    ds_read_b128 a[160:163], v2 offset:256
    ds_read_b128 a[164:167], v2 offset:320
    v_mfma_f32_16x16x32_bf16 v[56:59], a[200:203], a[56:59], v[56:59]
    v_exp_f32 v49, v49
    v_mfma_f32_16x16x32_bf16 v[60:63], a[200:203], a[88:91], v[60:63]
    v_exp_f32 v50, v50
    v_mfma_f32_16x16x32_bf16 v[52:55], a[204:207], a[28:31], v[52:55]
    v_cvt_pk_bf16_f32 v165, v46, v47
    v_cvt_pk_bf16_f32 v168, v48, v49
    v_mfma_f32_16x16x32_bf16 v[56:59], a[204:207], a[60:63], v[56:59]
    v_exp_f32 v51, v51
    v_mfma_f32_16x16x32_bf16 v[60:63], a[204:207], a[92:95], v[60:63]
    v_cvt_pk_bf16_f32 v169, v50, v51
    s_waitcnt lgkmcnt(4)
    v_mfma_f32_16x16x32_bf16 v[40:43], a[144:147], a[0:3], v[28:31]
    ds_read_b128 a[168:171], v2 offset:384
    ds_read_b128 a[172:175], v2 offset:448
    v_mfma_f32_16x16x32_bf16 v[44:47], a[144:147], a[32:35], v[32:35]
    v_exp_f32 v52, v52
    v_mfma_f32_16x16x32_bf16 v[48:51], a[144:147], a[64:67], v[36:39]
    v_exp_f32 v53, v53
    v_mfma_f32_16x16x32_bf16 v[40:43], a[148:151], a[4:7], v[40:43]
    buffer_load_dwordx4 v7, s[12:15], s30 offen offset:2112 nt lds
    v_mfma_f32_16x16x32_bf16 v[44:47], a[148:151], a[36:39], v[44:47]
    v_exp_f32 v54, v54
    v_mfma_f32_16x16x32_bf16 v[48:51], a[148:151], a[68:71], v[48:51]
    v_cvt_pk_bf16_f32 v162, v52, v53
    s_waitcnt lgkmcnt(4)
    v_mfma_f32_16x16x32_bf16 v[40:43], a[152:155], a[8:11], v[40:43]
    ds_read_b128 a[176:179], v2 offset:8448
    ds_read_b128 a[180:183], v2 offset:8512
    v_mfma_f32_16x16x32_bf16 v[44:47], a[152:155], a[40:43], v[44:47]
    v_exp_f32 v55, v55
    v_mfma_f32_16x16x32_bf16 v[48:51], a[152:155], a[72:75], v[48:51]
    v_exp_f32 v56, v56
    v_mfma_f32_16x16x32_bf16 v[40:43], a[156:159], a[12:15], v[40:43]
    v_cvt_pk_bf16_f32 v163, v54, v55
    v_mfma_f32_16x16x32_bf16 v[44:47], a[156:159], a[44:47], v[44:47]
    v_exp_f32 v57, v57
    v_mfma_f32_16x16x32_bf16 v[48:51], a[156:159], a[76:79], v[48:51]
    v_cvt_pk_bf16_f32 v166, v56, v57
    s_waitcnt lgkmcnt(4)
    v_mfma_f32_16x16x32_bf16 v[40:43], a[160:163], a[16:19], v[40:43]
    ds_read_b128 a[184:187], v2 offset:8576
    ds_read_b128 a[188:191], v2 offset:8640
    v_mfma_f32_16x16x32_bf16 v[44:47], a[160:163], a[48:51], v[44:47]
    v_exp_f32 v58, v58
    v_mfma_f32_16x16x32_bf16 v[48:51], a[160:163], a[80:83], v[48:51]
    v_exp_f32 v59, v59
    v_mfma_f32_16x16x32_bf16 v[40:43], a[164:167], a[20:23], v[40:43]
    buffer_load_dwordx4 v8, s[12:15], s30 offen offset:3168 nt lds
    v_mfma_f32_16x16x32_bf16 v[44:47], a[164:167], a[52:55], v[44:47]
    v_exp_f32 v60, v60
    v_mfma_f32_16x16x32_bf16 v[48:51], a[164:167], a[84:87], v[48:51]
    v_cvt_pk_bf16_f32 v167, v58, v59
    s_waitcnt lgkmcnt(4)
    v_mfma_f32_16x16x32_bf16 v[40:43], a[168:171], a[24:27], v[40:43]
    ds_read_b128 a[192:195], v2 offset:8704
    ds_read_b128 a[196:199], v2 offset:8768
    v_mfma_f32_16x16x32_bf16 v[44:47], a[168:171], a[56:59], v[44:47]
    v_exp_f32 v61, v61
    v_mfma_f32_16x16x32_bf16 v[48:51], a[168:171], a[88:91], v[48:51]
    v_exp_f32 v62, v62
    v_mfma_f32_16x16x32_bf16 v[40:43], a[172:175], a[28:31], v[40:43]
    v_cvt_pk_bf16_f32 v170, v60, v61
    v_mfma_f32_16x16x32_bf16 v[44:47], a[172:175], a[60:63], v[44:47]
    v_exp_f32 v63, v63
    v_mfma_f32_16x16x32_bf16 v[48:51], a[172:175], a[92:95], v[48:51]
    v_cvt_pk_bf16_f32 v171, v62, v63
    s_waitcnt lgkmcnt(4)
    v_mfma_f32_16x16x32_bf16 a[128:131], a[140:143], v[160:163], a[128:131]
    s_add_u32 m0, s28, 84480
    s_mov_b32 s30, 229376
    v_mfma_f32_16x16x32_bf16 a[132:135], a[140:143], v[164:167], a[132:135]
    v_mfma_f32_16x16x32_bf16 a[136:139], a[140:143], v[168:171], a[136:139]
    v_mfma_f32_16x16x32_bf16 v[52:55], a[176:179], a[0:3], v[28:31]
    ds_read_b128 a[200:203], v2 offset:8832
    ds_read_b128 a[204:207], v2 offset:8896
    v_mfma_f32_16x16x32_bf16 v[56:59], a[176:179], a[32:35], v[32:35]
    v_exp_f32 v40, v40
    v_mfma_f32_16x16x32_bf16 v[60:63], a[176:179], a[64:67], v[36:39]
    v_exp_f32 v41, v41
    v_mfma_f32_16x16x32_bf16 v[52:55], a[180:183], a[4:7], v[52:55]
    s_waitcnt vmcnt(8)
    s_barrier
    v_mfma_f32_16x16x32_bf16 v[56:59], a[180:183], a[36:39], v[56:59]
    v_exp_f32 v42, v42
    v_mfma_f32_16x16x32_bf16 v[60:63], a[180:183], a[68:71], v[60:63]
    v_cvt_pk_bf16_f32 v172, v40, v41
    s_waitcnt lgkmcnt(4)
    v_mfma_f32_16x16x32_bf16 v[52:55], a[184:187], a[8:11], v[52:55]
    ds_read_b128 a[144:147], v2 offset:16896
    ds_read_b128 a[148:151], v2 offset:16960
    v_mfma_f32_16x16x32_bf16 v[56:59], a[184:187], a[40:43], v[56:59]
    buffer_load_dwordx4 v5, s[12:15], s30 offen offset:0 nt lds
    v_exp_f32 v43, v43
    v_mfma_f32_16x16x32_bf16 v[60:63], a[184:187], a[72:75], v[60:63]
    v_exp_f32 v44, v44
    v_mfma_f32_16x16x32_bf16 v[52:55], a[188:191], a[12:15], v[52:55]
    buffer_load_dwordx4 v6, s[12:15], s30 offen offset:1056 nt lds
    v_mfma_f32_16x16x32_bf16 v[56:59], a[188:191], a[44:47], v[56:59]
    v_exp_f32 v45, v45
    v_mfma_f32_16x16x32_bf16 v[60:63], a[188:191], a[76:79], v[60:63]
    v_cvt_pk_bf16_f32 v173, v42, v43
    s_waitcnt lgkmcnt(4)
    v_mfma_f32_16x16x32_bf16 v[52:55], a[192:195], a[16:19], v[52:55]
    ds_read_b128 a[152:155], v2 offset:17024
    ds_read_b128 a[156:159], v2 offset:17088
    v_mfma_f32_16x16x32_bf16 v[56:59], a[192:195], a[48:51], v[56:59]
    buffer_load_dwordx4 v7, s[12:15], s30 offen offset:2112 nt lds
    v_exp_f32 v46, v46
    v_mfma_f32_16x16x32_bf16 v[60:63], a[192:195], a[80:83], v[60:63]
    v_exp_f32 v47, v47
    v_mfma_f32_16x16x32_bf16 v[52:55], a[196:199], a[20:23], v[52:55]
    buffer_load_dwordx4 v8, s[12:15], s30 offen offset:3168 nt lds
    v_mfma_f32_16x16x32_bf16 v[56:59], a[196:199], a[52:55], v[56:59]
    v_exp_f32 v48, v48
    v_mfma_f32_16x16x32_bf16 v[60:63], a[196:199], a[84:87], v[60:63]
    v_cvt_pk_bf16_f32 v176, v44, v45
    s_waitcnt lgkmcnt(4)
    v_mfma_f32_16x16x32_bf16 v[52:55], a[200:203], a[24:27], v[52:55]
    ds_read_b128 a[160:163], v2 offset:17152
    ds_read_b128 a[164:167], v2 offset:17216
    v_mfma_f32_16x16x32_bf16 v[56:59], a[200:203], a[56:59], v[56:59]
    s_add_u32 m0, s28, 101376
    s_mov_b32 s30, 245760
    v_exp_f32 v49, v49
    v_mfma_f32_16x16x32_bf16 v[60:63], a[200:203], a[88:91], v[60:63]
    v_exp_f32 v50, v50
    v_mfma_f32_16x16x32_bf16 v[52:55], a[204:207], a[28:31], v[52:55]
    v_cvt_pk_bf16_f32 v177, v46, v47
    v_cvt_pk_bf16_f32 v180, v48, v49
    v_mfma_f32_16x16x32_bf16 v[56:59], a[204:207], a[60:63], v[56:59]
    buffer_load_dwordx4 v5, s[12:15], s30 offen offset:0 nt lds
    v_exp_f32 v51, v51
    v_mfma_f32_16x16x32_bf16 v[60:63], a[204:207], a[92:95], v[60:63]
    v_cvt_pk_bf16_f32 v181, v50, v51
    s_waitcnt lgkmcnt(4)
    v_mfma_f32_16x16x32_bf16 v[40:43], a[144:147], a[0:3], v[28:31]
    ds_read_b128 a[168:171], v2 offset:17280
    ds_read_b128 a[172:175], v2 offset:17344
    v_mfma_f32_16x16x32_bf16 v[44:47], a[144:147], a[32:35], v[32:35]
    v_exp_f32 v52, v52
    v_mfma_f32_16x16x32_bf16 v[48:51], a[144:147], a[64:67], v[36:39]
    v_exp_f32 v53, v53
    v_mfma_f32_16x16x32_bf16 v[40:43], a[148:151], a[4:7], v[40:43]
    buffer_load_dwordx4 v6, s[12:15], s30 offen offset:1056 nt lds
    v_mfma_f32_16x16x32_bf16 v[44:47], a[148:151], a[36:39], v[44:47]
    v_exp_f32 v54, v54
    v_mfma_f32_16x16x32_bf16 v[48:51], a[148:151], a[68:71], v[48:51]
    v_cvt_pk_bf16_f32 v174, v52, v53
    s_waitcnt lgkmcnt(4)
    v_mfma_f32_16x16x32_bf16 v[40:43], a[152:155], a[8:11], v[40:43]
    ds_read_b128 a[176:179], v2 offset:25344
    ds_read_b128 a[180:183], v2 offset:25408
    v_mfma_f32_16x16x32_bf16 v[44:47], a[152:155], a[40:43], v[44:47]
    buffer_load_dwordx4 v7, s[12:15], s30 offen offset:2112 nt lds
    v_exp_f32 v55, v55
    v_mfma_f32_16x16x32_bf16 v[48:51], a[152:155], a[72:75], v[48:51]
    v_exp_f32 v56, v56
    v_mfma_f32_16x16x32_bf16 v[40:43], a[156:159], a[12:15], v[40:43]
    v_cvt_pk_bf16_f32 v175, v54, v55
    v_mfma_f32_16x16x32_bf16 v[44:47], a[156:159], a[44:47], v[44:47]
    v_exp_f32 v57, v57
    v_mfma_f32_16x16x32_bf16 v[48:51], a[156:159], a[76:79], v[48:51]
    v_cvt_pk_bf16_f32 v178, v56, v57
    s_waitcnt lgkmcnt(4)
    v_mfma_f32_16x16x32_bf16 v[40:43], a[160:163], a[16:19], v[40:43]
    ds_read_b128 a[184:187], v2 offset:25472
    ds_read_b128 a[188:191], v2 offset:25536
    v_mfma_f32_16x16x32_bf16 v[44:47], a[160:163], a[48:51], v[44:47]
    v_exp_f32 v58, v58
    v_mfma_f32_16x16x32_bf16 v[48:51], a[160:163], a[80:83], v[48:51]
    v_exp_f32 v59, v59
    v_mfma_f32_16x16x32_bf16 v[40:43], a[164:167], a[20:23], v[40:43]
    buffer_load_dwordx4 v8, s[12:15], s30 offen offset:3168 nt lds
    v_mfma_f32_16x16x32_bf16 v[44:47], a[164:167], a[52:55], v[44:47]
    v_exp_f32 v60, v60
    v_mfma_f32_16x16x32_bf16 v[48:51], a[164:167], a[84:87], v[48:51]
    v_cvt_pk_bf16_f32 v179, v58, v59
    s_waitcnt lgkmcnt(4)
    v_mfma_f32_16x16x32_bf16 v[40:43], a[168:171], a[24:27], v[40:43]
    ds_read_b128 a[192:195], v2 offset:25600
    ds_read_b128 a[196:199], v2 offset:25664
    v_mfma_f32_16x16x32_bf16 v[44:47], a[168:171], a[56:59], v[44:47]
    v_exp_f32 v61, v61
    v_mfma_f32_16x16x32_bf16 v[48:51], a[168:171], a[88:91], v[48:51]
    v_exp_f32 v62, v62
    v_mfma_f32_16x16x32_bf16 v[40:43], a[172:175], a[28:31], v[40:43]
    v_cvt_pk_bf16_f32 v182, v60, v61
    v_mfma_f32_16x16x32_bf16 v[44:47], a[172:175], a[60:63], v[44:47]
    v_exp_f32 v63, v63
    v_mfma_f32_16x16x32_bf16 v[48:51], a[172:175], a[92:95], v[48:51]
    v_cvt_pk_bf16_f32 v183, v62, v63
    s_waitcnt lgkmcnt(4)
    v_mfma_f32_16x16x32_bf16 a[128:131], a[140:143], v[172:175], a[128:131]
    s_add_u32 m0, s29, 118272
    s_mov_b32 s30, 0
    v_mfma_f32_16x16x32_bf16 a[132:135], a[140:143], v[176:179], a[132:135]
    v_mfma_f32_16x16x32_bf16 a[136:139], a[140:143], v[180:183], a[136:139]
    v_mfma_f32_16x16x32_bf16 v[52:55], a[176:179], a[0:3], v[28:31]
    ds_read_b128 a[200:203], v2 offset:25728
    ds_read_b128 a[204:207], v2 offset:25792
    v_mfma_f32_16x16x32_bf16 v[56:59], a[176:179], a[32:35], v[32:35]
    v_exp_f32 v40, v40
    v_mfma_f32_16x16x32_bf16 v[60:63], a[176:179], a[64:67], v[36:39]
    v_exp_f32 v41, v41
    v_mfma_f32_16x16x32_bf16 v[52:55], a[180:183], a[4:7], v[52:55]
    v_mfma_f32_16x16x32_bf16 v[56:59], a[180:183], a[36:39], v[56:59]
    v_exp_f32 v42, v42
    v_mfma_f32_16x16x32_bf16 v[60:63], a[180:183], a[68:71], v[60:63]
    v_cvt_pk_bf16_f32 v184, v40, v41
    s_waitcnt lgkmcnt(4)
    v_mfma_f32_16x16x32_bf16 v[52:55], a[184:187], a[8:11], v[52:55]
    ds_read_b128 a[144:147], v2 offset:33792
    ds_read_b128 a[148:151], v2 offset:33856
    v_mfma_f32_16x16x32_bf16 v[56:59], a[184:187], a[40:43], v[56:59]
    v_exp_f32 v43, v43
    v_mfma_f32_16x16x32_bf16 v[60:63], a[184:187], a[72:75], v[60:63]
    v_exp_f32 v44, v44
    v_mfma_f32_16x16x32_bf16 v[52:55], a[188:191], a[12:15], v[52:55]
    buffer_load_dwordx4 v9, s[16:19], s30 offen offset:0 nt lds
    v_mfma_f32_16x16x32_bf16 v[56:59], a[188:191], a[44:47], v[56:59]
    v_exp_f32 v45, v45
    v_mfma_f32_16x16x32_bf16 v[60:63], a[188:191], a[76:79], v[60:63]
    v_cvt_pk_bf16_f32 v185, v42, v43
    s_waitcnt lgkmcnt(4)
    v_mfma_f32_16x16x32_bf16 v[52:55], a[192:195], a[16:19], v[52:55]
    ds_read_b128 a[152:155], v2 offset:33920
    ds_read_b128 a[156:159], v2 offset:33984
    v_mfma_f32_16x16x32_bf16 v[56:59], a[192:195], a[48:51], v[56:59]
    v_exp_f32 v46, v46
    v_mfma_f32_16x16x32_bf16 v[60:63], a[192:195], a[80:83], v[60:63]
    v_exp_f32 v47, v47
    v_mfma_f32_16x16x32_bf16 v[52:55], a[196:199], a[20:23], v[52:55]
    buffer_load_dwordx4 v10, s[16:19], s30 offen offset:1032 nt lds
    v_mfma_f32_16x16x32_bf16 v[56:59], a[196:199], a[52:55], v[56:59]
    v_exp_f32 v48, v48
    v_mfma_f32_16x16x32_bf16 v[60:63], a[196:199], a[84:87], v[60:63]
    v_cvt_pk_bf16_f32 v188, v44, v45
    s_waitcnt lgkmcnt(4)
    v_mfma_f32_16x16x32_bf16 v[52:55], a[200:203], a[24:27], v[52:55]
    ds_read_b128 a[160:163], v2 offset:34048
    ds_read_b128 a[164:167], v2 offset:34112
    v_mfma_f32_16x16x32_bf16 v[56:59], a[200:203], a[56:59], v[56:59]
    v_exp_f32 v49, v49
    v_mfma_f32_16x16x32_bf16 v[60:63], a[200:203], a[88:91], v[60:63]
    v_exp_f32 v50, v50
    v_mfma_f32_16x16x32_bf16 v[52:55], a[204:207], a[28:31], v[52:55]
    v_cvt_pk_bf16_f32 v189, v46, v47
    v_cvt_pk_bf16_f32 v192, v48, v49
    v_mfma_f32_16x16x32_bf16 v[56:59], a[204:207], a[60:63], v[56:59]
    v_exp_f32 v51, v51
    v_mfma_f32_16x16x32_bf16 v[60:63], a[204:207], a[92:95], v[60:63]
    v_cvt_pk_bf16_f32 v193, v50, v51
    s_waitcnt lgkmcnt(4)
    v_mfma_f32_16x16x32_bf16 v[40:43], a[144:147], a[0:3], v[28:31]
    ds_read_b128 a[168:171], v2 offset:34176
    ds_read_b128 a[172:175], v2 offset:34240
    v_mfma_f32_16x16x32_bf16 v[44:47], a[144:147], a[32:35], v[32:35]
    v_exp_f32 v52, v52
    v_mfma_f32_16x16x32_bf16 v[48:51], a[144:147], a[64:67], v[36:39]
    v_exp_f32 v53, v53
    v_mfma_f32_16x16x32_bf16 v[40:43], a[148:151], a[4:7], v[40:43]
    buffer_load_dwordx4 v11, s[16:19], s30 offen offset:2064 nt lds
    v_mfma_f32_16x16x32_bf16 v[44:47], a[148:151], a[36:39], v[44:47]
    v_exp_f32 v54, v54
    v_mfma_f32_16x16x32_bf16 v[48:51], a[148:151], a[68:71], v[48:51]
    v_cvt_pk_bf16_f32 v186, v52, v53
    s_waitcnt lgkmcnt(4)
    v_mfma_f32_16x16x32_bf16 v[40:43], a[152:155], a[8:11], v[40:43]
    ds_read_b128 a[176:179], v2 offset:42240
    ds_read_b128 a[180:183], v2 offset:42304
    v_mfma_f32_16x16x32_bf16 v[44:47], a[152:155], a[40:43], v[44:47]
    v_exp_f32 v55, v55
    v_mfma_f32_16x16x32_bf16 v[48:51], a[152:155], a[72:75], v[48:51]
    v_exp_f32 v56, v56
    v_mfma_f32_16x16x32_bf16 v[40:43], a[156:159], a[12:15], v[40:43]
    v_cvt_pk_bf16_f32 v187, v54, v55
    v_mfma_f32_16x16x32_bf16 v[44:47], a[156:159], a[44:47], v[44:47]
    v_exp_f32 v57, v57
    v_mfma_f32_16x16x32_bf16 v[48:51], a[156:159], a[76:79], v[48:51]
    v_cvt_pk_bf16_f32 v190, v56, v57
    s_waitcnt lgkmcnt(4)
    v_mfma_f32_16x16x32_bf16 v[40:43], a[160:163], a[16:19], v[40:43]
    ds_read_b128 a[184:187], v2 offset:42368
    ds_read_b128 a[188:191], v2 offset:42432
    v_mfma_f32_16x16x32_bf16 v[44:47], a[160:163], a[48:51], v[44:47]
    v_exp_f32 v58, v58
    v_mfma_f32_16x16x32_bf16 v[48:51], a[160:163], a[80:83], v[48:51]
    v_exp_f32 v59, v59
    v_mfma_f32_16x16x32_bf16 v[40:43], a[164:167], a[20:23], v[40:43]
    buffer_load_dwordx4 v12, s[16:19], s30 offen offset:3096 nt lds
    v_mfma_f32_16x16x32_bf16 v[44:47], a[164:167], a[52:55], v[44:47]
    v_exp_f32 v60, v60
    v_mfma_f32_16x16x32_bf16 v[48:51], a[164:167], a[84:87], v[48:51]
    v_cvt_pk_bf16_f32 v191, v58, v59
    s_waitcnt lgkmcnt(4)
    v_mfma_f32_16x16x32_bf16 v[40:43], a[168:171], a[24:27], v[40:43]
    ds_read_b128 a[192:195], v2 offset:42496
    ds_read_b128 a[196:199], v2 offset:42560
    v_mfma_f32_16x16x32_bf16 v[44:47], a[168:171], a[56:59], v[44:47]
    v_exp_f32 v61, v61
    v_mfma_f32_16x16x32_bf16 v[48:51], a[168:171], a[88:91], v[48:51]
    v_exp_f32 v62, v62
    v_mfma_f32_16x16x32_bf16 v[40:43], a[172:175], a[28:31], v[40:43]
    v_cvt_pk_bf16_f32 v194, v60, v61
    v_mfma_f32_16x16x32_bf16 v[44:47], a[172:175], a[60:63], v[44:47]
    v_exp_f32 v63, v63
    v_mfma_f32_16x16x32_bf16 v[48:51], a[172:175], a[92:95], v[48:51]
    v_cvt_pk_bf16_f32 v195, v62, v63
    s_waitcnt lgkmcnt(4)
    v_mfma_f32_16x16x32_bf16 a[128:131], a[140:143], v[184:187], a[128:131]
    s_add_u32 m0, s29, 135168
    s_mov_b32 s30, 65536
    v_mfma_f32_16x16x32_bf16 a[132:135], a[140:143], v[188:191], a[132:135]
    v_mfma_f32_16x16x32_bf16 a[136:139], a[140:143], v[192:195], a[136:139]
    v_mfma_f32_16x16x32_bf16 v[52:55], a[176:179], a[0:3], v[28:31]
    ds_read_b128 a[200:203], v2 offset:42624
    ds_read_b128 a[204:207], v2 offset:42688
    v_mfma_f32_16x16x32_bf16 v[56:59], a[176:179], a[32:35], v[32:35]
    v_exp_f32 v40, v40
    v_mfma_f32_16x16x32_bf16 v[60:63], a[176:179], a[64:67], v[36:39]
    v_exp_f32 v41, v41
    v_mfma_f32_16x16x32_bf16 v[52:55], a[180:183], a[4:7], v[52:55]
    s_waitcnt vmcnt(12)
    s_barrier
    v_mfma_f32_16x16x32_bf16 v[56:59], a[180:183], a[36:39], v[56:59]
    v_exp_f32 v42, v42
    v_mfma_f32_16x16x32_bf16 v[60:63], a[180:183], a[68:71], v[60:63]
    v_cvt_pk_bf16_f32 v196, v40, v41
    s_waitcnt lgkmcnt(4)
    v_mfma_f32_16x16x32_bf16 v[52:55], a[184:187], a[8:11], v[52:55]
    ds_read_b128 a[144:147], v3 offset:0
    ds_read_b128 a[148:151], v3 offset:64
    v_mfma_f32_16x16x32_bf16 v[56:59], a[184:187], a[40:43], v[56:59]
    buffer_load_dwordx4 v9, s[16:19], s30 offen offset:0 nt lds
    v_exp_f32 v43, v43
    v_mfma_f32_16x16x32_bf16 v[60:63], a[184:187], a[72:75], v[60:63]
    v_exp_f32 v44, v44
    v_mfma_f32_16x16x32_bf16 v[52:55], a[188:191], a[12:15], v[52:55]
    buffer_load_dwordx4 v10, s[16:19], s30 offen offset:1032 nt lds
    v_mfma_f32_16x16x32_bf16 v[56:59], a[188:191], a[44:47], v[56:59]
    v_exp_f32 v45, v45
    v_mfma_f32_16x16x32_bf16 v[60:63], a[188:191], a[76:79], v[60:63]
    v_cvt_pk_bf16_f32 v197, v42, v43
    s_waitcnt lgkmcnt(4)
    v_mfma_f32_16x16x32_bf16 v[52:55], a[192:195], a[16:19], v[52:55]
    ds_read_b128 a[152:155], v3 offset:128
    ds_read_b128 a[156:159], v3 offset:192
    v_mfma_f32_16x16x32_bf16 v[56:59], a[192:195], a[48:51], v[56:59]
    buffer_load_dwordx4 v11, s[16:19], s30 offen offset:2064 nt lds
    v_exp_f32 v46, v46
    v_mfma_f32_16x16x32_bf16 v[60:63], a[192:195], a[80:83], v[60:63]
    v_exp_f32 v47, v47
    v_mfma_f32_16x16x32_bf16 v[52:55], a[196:199], a[20:23], v[52:55]
    buffer_load_dwordx4 v12, s[16:19], s30 offen offset:3096 nt lds
    v_mfma_f32_16x16x32_bf16 v[56:59], a[196:199], a[52:55], v[56:59]
    v_exp_f32 v48, v48
    v_mfma_f32_16x16x32_bf16 v[60:63], a[196:199], a[84:87], v[60:63]
    v_cvt_pk_bf16_f32 v200, v44, v45
    s_waitcnt lgkmcnt(4)
    v_mfma_f32_16x16x32_bf16 v[52:55], a[200:203], a[24:27], v[52:55]
    ds_read_b128 a[160:163], v3 offset:256
    ds_read_b128 a[164:167], v3 offset:320
    v_mfma_f32_16x16x32_bf16 v[56:59], a[200:203], a[56:59], v[56:59]
    s_add_u32 m0, s29, 0
    s_mov_b32 s30, 131072
    v_exp_f32 v49, v49
    v_mfma_f32_16x16x32_bf16 v[60:63], a[200:203], a[88:91], v[60:63]
    v_exp_f32 v50, v50
    v_mfma_f32_16x16x32_bf16 v[52:55], a[204:207], a[28:31], v[52:55]
    v_cvt_pk_bf16_f32 v201, v46, v47
    v_cvt_pk_bf16_f32 v204, v48, v49
    v_mfma_f32_16x16x32_bf16 v[56:59], a[204:207], a[60:63], v[56:59]
    buffer_load_dwordx4 v9, s[16:19], s30 offen offset:0 nt lds
    v_exp_f32 v51, v51
    v_mfma_f32_16x16x32_bf16 v[60:63], a[204:207], a[92:95], v[60:63]
    v_cvt_pk_bf16_f32 v205, v50, v51
    s_waitcnt lgkmcnt(4)
    v_mfma_f32_16x16x32_bf16 v[40:43], a[144:147], a[0:3], v[28:31]
    ds_read_b128 a[168:171], v3 offset:384
    ds_read_b128 a[172:175], v3 offset:448
    v_mfma_f32_16x16x32_bf16 v[44:47], a[144:147], a[32:35], v[32:35]
    v_exp_f32 v52, v52
    v_mfma_f32_16x16x32_bf16 v[48:51], a[144:147], a[64:67], v[36:39]
    v_exp_f32 v53, v53
    v_mfma_f32_16x16x32_bf16 v[40:43], a[148:151], a[4:7], v[40:43]
    buffer_load_dwordx4 v10, s[16:19], s30 offen offset:1032 nt lds
    v_mfma_f32_16x16x32_bf16 v[44:47], a[148:151], a[36:39], v[44:47]
    v_exp_f32 v54, v54
    v_mfma_f32_16x16x32_bf16 v[48:51], a[148:151], a[68:71], v[48:51]
    v_cvt_pk_bf16_f32 v198, v52, v53
    s_waitcnt lgkmcnt(4)
    v_mfma_f32_16x16x32_bf16 v[40:43], a[152:155], a[8:11], v[40:43]
    ds_read_b128 a[176:179], v3 offset:8448
    ds_read_b128 a[180:183], v3 offset:8512
    v_mfma_f32_16x16x32_bf16 v[44:47], a[152:155], a[40:43], v[44:47]
    buffer_load_dwordx4 v11, s[16:19], s30 offen offset:2064 nt lds
    v_exp_f32 v55, v55
    v_mfma_f32_16x16x32_bf16 v[48:51], a[152:155], a[72:75], v[48:51]
    v_exp_f32 v56, v56
    v_mfma_f32_16x16x32_bf16 v[40:43], a[156:159], a[12:15], v[40:43]
    v_cvt_pk_bf16_f32 v199, v54, v55
    v_mfma_f32_16x16x32_bf16 v[44:47], a[156:159], a[44:47], v[44:47]
    v_exp_f32 v57, v57
    v_mfma_f32_16x16x32_bf16 v[48:51], a[156:159], a[76:79], v[48:51]
    v_cvt_pk_bf16_f32 v202, v56, v57
    s_waitcnt lgkmcnt(4)
    v_mfma_f32_16x16x32_bf16 v[40:43], a[160:163], a[16:19], v[40:43]
    ds_read_b128 a[184:187], v3 offset:8576
    ds_read_b128 a[188:191], v3 offset:8640
    v_mfma_f32_16x16x32_bf16 v[44:47], a[160:163], a[48:51], v[44:47]
    v_exp_f32 v58, v58
    v_mfma_f32_16x16x32_bf16 v[48:51], a[160:163], a[80:83], v[48:51]
    v_exp_f32 v59, v59
    v_mfma_f32_16x16x32_bf16 v[40:43], a[164:167], a[20:23], v[40:43]
    buffer_load_dwordx4 v12, s[16:19], s30 offen offset:3096 nt lds
    v_mfma_f32_16x16x32_bf16 v[44:47], a[164:167], a[52:55], v[44:47]
    v_exp_f32 v60, v60
    v_mfma_f32_16x16x32_bf16 v[48:51], a[164:167], a[84:87], v[48:51]
    v_cvt_pk_bf16_f32 v203, v58, v59
    s_waitcnt lgkmcnt(4)
    v_mfma_f32_16x16x32_bf16 v[40:43], a[168:171], a[24:27], v[40:43]
    ds_read_b128 a[192:195], v3 offset:8704
    ds_read_b128 a[196:199], v3 offset:8768
    v_mfma_f32_16x16x32_bf16 v[44:47], a[168:171], a[56:59], v[44:47]
    v_exp_f32 v61, v61
    v_mfma_f32_16x16x32_bf16 v[48:51], a[168:171], a[88:91], v[48:51]
    v_exp_f32 v62, v62
    v_mfma_f32_16x16x32_bf16 v[40:43], a[172:175], a[28:31], v[40:43]
    v_cvt_pk_bf16_f32 v206, v60, v61
    v_mfma_f32_16x16x32_bf16 v[44:47], a[172:175], a[60:63], v[44:47]
    v_exp_f32 v63, v63
    v_mfma_f32_16x16x32_bf16 v[48:51], a[172:175], a[92:95], v[48:51]
    v_cvt_pk_bf16_f32 v207, v62, v63
    s_waitcnt lgkmcnt(4)
    v_mfma_f32_16x16x32_bf16 a[128:131], a[140:143], v[196:199], a[128:131]
    s_add_u32 m0, s29, 16896
    s_mov_b32 s30, 196608
    v_mfma_f32_16x16x32_bf16 a[132:135], a[140:143], v[200:203], a[132:135]
    v_mfma_f32_16x16x32_bf16 a[136:139], a[140:143], v[204:207], a[136:139]
    v_mfma_f32_16x16x32_bf16 v[52:55], a[176:179], a[0:3], v[28:31]
    ds_read_b128 a[200:203], v3 offset:8832
    ds_read_b128 a[204:207], v3 offset:8896
    v_mfma_f32_16x16x32_bf16 v[56:59], a[176:179], a[32:35], v[32:35]
    v_exp_f32 v40, v40
    v_mfma_f32_16x16x32_bf16 v[60:63], a[176:179], a[64:67], v[36:39]
    v_exp_f32 v41, v41
    v_mfma_f32_16x16x32_bf16 v[52:55], a[180:183], a[4:7], v[52:55]
    v_mfma_f32_16x16x32_bf16 v[56:59], a[180:183], a[36:39], v[56:59]
    v_exp_f32 v42, v42
    v_mfma_f32_16x16x32_bf16 v[60:63], a[180:183], a[68:71], v[60:63]
    v_cvt_pk_bf16_f32 v208, v40, v41
    s_waitcnt lgkmcnt(4)
    v_mfma_f32_16x16x32_bf16 v[52:55], a[184:187], a[8:11], v[52:55]
    ds_read_b128 a[144:147], v3 offset:16896
    ds_read_b128 a[148:151], v3 offset:16960
    v_mfma_f32_16x16x32_bf16 v[56:59], a[184:187], a[40:43], v[56:59]
    v_exp_f32 v43, v43
    v_mfma_f32_16x16x32_bf16 v[60:63], a[184:187], a[72:75], v[60:63]
    v_exp_f32 v44, v44
    v_mfma_f32_16x16x32_bf16 v[52:55], a[188:191], a[12:15], v[52:55]
    buffer_load_dwordx4 v9, s[16:19], s30 offen offset:0 nt lds
    v_mfma_f32_16x16x32_bf16 v[56:59], a[188:191], a[44:47], v[56:59]
    v_exp_f32 v45, v45
    v_mfma_f32_16x16x32_bf16 v[60:63], a[188:191], a[76:79], v[60:63]
    v_cvt_pk_bf16_f32 v209, v42, v43
    s_waitcnt lgkmcnt(4)
    v_mfma_f32_16x16x32_bf16 v[52:55], a[192:195], a[16:19], v[52:55]
    ds_read_b128 a[152:155], v3 offset:17024
    ds_read_b128 a[156:159], v3 offset:17088
    v_mfma_f32_16x16x32_bf16 v[56:59], a[192:195], a[48:51], v[56:59]
    v_exp_f32 v46, v46
    v_mfma_f32_16x16x32_bf16 v[60:63], a[192:195], a[80:83], v[60:63]
    v_exp_f32 v47, v47
    v_mfma_f32_16x16x32_bf16 v[52:55], a[196:199], a[20:23], v[52:55]
    buffer_load_dwordx4 v10, s[16:19], s30 offen offset:1032 nt lds
    v_mfma_f32_16x16x32_bf16 v[56:59], a[196:199], a[52:55], v[56:59]
    v_exp_f32 v48, v48
    v_mfma_f32_16x16x32_bf16 v[60:63], a[196:199], a[84:87], v[60:63]
    v_cvt_pk_bf16_f32 v212, v44, v45
    s_waitcnt lgkmcnt(4)
    v_mfma_f32_16x16x32_bf16 v[52:55], a[200:203], a[24:27], v[52:55]
    ds_read_b128 a[160:163], v3 offset:17152
    ds_read_b128 a[164:167], v3 offset:17216
    v_mfma_f32_16x16x32_bf16 v[56:59], a[200:203], a[56:59], v[56:59]
    v_exp_f32 v49, v49
    v_mfma_f32_16x16x32_bf16 v[60:63], a[200:203], a[88:91], v[60:63]
    v_exp_f32 v50, v50
    v_mfma_f32_16x16x32_bf16 v[52:55], a[204:207], a[28:31], v[52:55]
    v_cvt_pk_bf16_f32 v213, v46, v47
    v_cvt_pk_bf16_f32 v216, v48, v49
    v_mfma_f32_16x16x32_bf16 v[56:59], a[204:207], a[60:63], v[56:59]
    v_exp_f32 v51, v51
    v_mfma_f32_16x16x32_bf16 v[60:63], a[204:207], a[92:95], v[60:63]
    v_cvt_pk_bf16_f32 v217, v50, v51
    s_waitcnt lgkmcnt(4)
    v_mfma_f32_16x16x32_bf16 v[40:43], a[144:147], a[0:3], v[28:31]
    ds_read_b128 a[168:171], v3 offset:17280
    ds_read_b128 a[172:175], v3 offset:17344
    v_mfma_f32_16x16x32_bf16 v[44:47], a[144:147], a[32:35], v[32:35]
    v_exp_f32 v52, v52
    v_mfma_f32_16x16x32_bf16 v[48:51], a[144:147], a[64:67], v[36:39]
    v_exp_f32 v53, v53
    v_mfma_f32_16x16x32_bf16 v[40:43], a[148:151], a[4:7], v[40:43]
    buffer_load_dwordx4 v11, s[16:19], s30 offen offset:2064 nt lds
    v_mfma_f32_16x16x32_bf16 v[44:47], a[148:151], a[36:39], v[44:47]
    v_exp_f32 v54, v54
    v_mfma_f32_16x16x32_bf16 v[48:51], a[148:151], a[68:71], v[48:51]
    v_cvt_pk_bf16_f32 v210, v52, v53
    s_waitcnt lgkmcnt(4)
    v_mfma_f32_16x16x32_bf16 v[40:43], a[152:155], a[8:11], v[40:43]
    ds_read_b128 a[176:179], v3 offset:25344
    ds_read_b128 a[180:183], v3 offset:25408
    v_mfma_f32_16x16x32_bf16 v[44:47], a[152:155], a[40:43], v[44:47]
    v_exp_f32 v55, v55
    v_mfma_f32_16x16x32_bf16 v[48:51], a[152:155], a[72:75], v[48:51]
    v_exp_f32 v56, v56
    v_mfma_f32_16x16x32_bf16 v[40:43], a[156:159], a[12:15], v[40:43]
    v_cvt_pk_bf16_f32 v211, v54, v55
    v_mfma_f32_16x16x32_bf16 v[44:47], a[156:159], a[44:47], v[44:47]
    v_exp_f32 v57, v57
    v_mfma_f32_16x16x32_bf16 v[48:51], a[156:159], a[76:79], v[48:51]
    v_cvt_pk_bf16_f32 v214, v56, v57
    s_waitcnt lgkmcnt(4)
    v_mfma_f32_16x16x32_bf16 v[40:43], a[160:163], a[16:19], v[40:43]
    ds_read_b128 a[184:187], v3 offset:25472
    ds_read_b128 a[188:191], v3 offset:25536
    v_mfma_f32_16x16x32_bf16 v[44:47], a[160:163], a[48:51], v[44:47]
    v_exp_f32 v58, v58
    v_mfma_f32_16x16x32_bf16 v[48:51], a[160:163], a[80:83], v[48:51]
    v_exp_f32 v59, v59
    v_mfma_f32_16x16x32_bf16 v[40:43], a[164:167], a[20:23], v[40:43]
    buffer_load_dwordx4 v12, s[16:19], s30 offen offset:3096 nt lds
    v_mfma_f32_16x16x32_bf16 v[44:47], a[164:167], a[52:55], v[44:47]
    v_exp_f32 v60, v60
    v_mfma_f32_16x16x32_bf16 v[48:51], a[164:167], a[84:87], v[48:51]
    v_cvt_pk_bf16_f32 v215, v58, v59
    s_waitcnt lgkmcnt(4)
    v_mfma_f32_16x16x32_bf16 v[40:43], a[168:171], a[24:27], v[40:43]
    ds_read_b128 a[192:195], v3 offset:25600
    ds_read_b128 a[196:199], v3 offset:25664
    v_mfma_f32_16x16x32_bf16 v[44:47], a[168:171], a[56:59], v[44:47]
    v_exp_f32 v61, v61
    v_mfma_f32_16x16x32_bf16 v[48:51], a[168:171], a[88:91], v[48:51]
    v_exp_f32 v62, v62
    v_mfma_f32_16x16x32_bf16 v[40:43], a[172:175], a[28:31], v[40:43]
    v_cvt_pk_bf16_f32 v218, v60, v61
    v_mfma_f32_16x16x32_bf16 v[44:47], a[172:175], a[60:63], v[44:47]
    v_exp_f32 v63, v63
    v_mfma_f32_16x16x32_bf16 v[48:51], a[172:175], a[92:95], v[48:51]
    v_cvt_pk_bf16_f32 v219, v62, v63
    s_waitcnt lgkmcnt(4)
    v_mfma_f32_16x16x32_bf16 a[128:131], a[140:143], v[208:211], a[128:131]
    s_add_u32 m0, s29, 33792
    s_mov_b32 s30, 128
    v_mfma_f32_16x16x32_bf16 a[132:135], a[140:143], v[212:215], a[132:135]
    v_mfma_f32_16x16x32_bf16 a[136:139], a[140:143], v[216:219], a[136:139]
    v_mfma_f32_16x16x32_bf16 v[52:55], a[176:179], a[0:3], v[28:31]
    ds_read_b128 a[200:203], v3 offset:25728
    ds_read_b128 a[204:207], v3 offset:25792
    v_mfma_f32_16x16x32_bf16 v[56:59], a[176:179], a[32:35], v[32:35]
    v_exp_f32 v40, v40
    v_mfma_f32_16x16x32_bf16 v[60:63], a[176:179], a[64:67], v[36:39]
    v_exp_f32 v41, v41
    v_mfma_f32_16x16x32_bf16 v[52:55], a[180:183], a[4:7], v[52:55]
    s_waitcnt vmcnt(16)
    s_barrier
    v_mfma_f32_16x16x32_bf16 v[56:59], a[180:183], a[36:39], v[56:59]
    v_exp_f32 v42, v42
    v_mfma_f32_16x16x32_bf16 v[60:63], a[180:183], a[68:71], v[60:63]
    v_cvt_pk_bf16_f32 v220, v40, v41
    s_waitcnt lgkmcnt(4)
    v_mfma_f32_16x16x32_bf16 v[52:55], a[184:187], a[8:11], v[52:55]
    ds_read_b128 a[144:147], v3 offset:33792
    ds_read_b128 a[148:151], v3 offset:33856
    v_mfma_f32_16x16x32_bf16 v[56:59], a[184:187], a[40:43], v[56:59]
    v_exp_f32 v43, v43
    v_mfma_f32_16x16x32_bf16 v[60:63], a[184:187], a[72:75], v[60:63]
    v_exp_f32 v44, v44
    v_mfma_f32_16x16x32_bf16 v[52:55], a[188:191], a[12:15], v[52:55]
    buffer_load_dwordx4 v9, s[16:19], s30 offen offset:0 nt lds
    v_mfma_f32_16x16x32_bf16 v[56:59], a[188:191], a[44:47], v[56:59]
    v_exp_f32 v45, v45
    v_mfma_f32_16x16x32_bf16 v[60:63], a[188:191], a[76:79], v[60:63]
    v_cvt_pk_bf16_f32 v221, v42, v43
    s_waitcnt lgkmcnt(4)
    v_mfma_f32_16x16x32_bf16 v[52:55], a[192:195], a[16:19], v[52:55]
    ds_read_b128 a[152:155], v3 offset:33920
    ds_read_b128 a[156:159], v3 offset:33984
    v_mfma_f32_16x16x32_bf16 v[56:59], a[192:195], a[48:51], v[56:59]
    v_exp_f32 v46, v46
    v_mfma_f32_16x16x32_bf16 v[60:63], a[192:195], a[80:83], v[60:63]
    v_exp_f32 v47, v47
    v_mfma_f32_16x16x32_bf16 v[52:55], a[196:199], a[20:23], v[52:55]
    buffer_load_dwordx4 v10, s[16:19], s30 offen offset:1032 nt lds
    v_mfma_f32_16x16x32_bf16 v[56:59], a[196:199], a[52:55], v[56:59]
    v_exp_f32 v48, v48
    v_mfma_f32_16x16x32_bf16 v[60:63], a[196:199], a[84:87], v[60:63]
    v_cvt_pk_bf16_f32 v224, v44, v45
    s_waitcnt lgkmcnt(4)
    v_mfma_f32_16x16x32_bf16 v[52:55], a[200:203], a[24:27], v[52:55]
    ds_read_b128 a[160:163], v3 offset:34048
    ds_read_b128 a[164:167], v3 offset:34112
    v_mfma_f32_16x16x32_bf16 v[56:59], a[200:203], a[56:59], v[56:59]
    v_exp_f32 v49, v49
    v_mfma_f32_16x16x32_bf16 v[60:63], a[200:203], a[88:91], v[60:63]
    v_exp_f32 v50, v50
    v_mfma_f32_16x16x32_bf16 v[52:55], a[204:207], a[28:31], v[52:55]
    v_cvt_pk_bf16_f32 v225, v46, v47
    v_cvt_pk_bf16_f32 v228, v48, v49
    v_mfma_f32_16x16x32_bf16 v[56:59], a[204:207], a[60:63], v[56:59]
    v_exp_f32 v51, v51
    v_mfma_f32_16x16x32_bf16 v[60:63], a[204:207], a[92:95], v[60:63]
    v_cvt_pk_bf16_f32 v229, v50, v51
    s_waitcnt lgkmcnt(4)
    v_mfma_f32_16x16x32_bf16 v[40:43], a[144:147], a[0:3], v[28:31]
    ds_read_b128 a[168:171], v3 offset:34176
    ds_read_b128 a[172:175], v3 offset:34240
    v_mfma_f32_16x16x32_bf16 v[44:47], a[144:147], a[32:35], v[32:35]
    v_exp_f32 v52, v52
    v_mfma_f32_16x16x32_bf16 v[48:51], a[144:147], a[64:67], v[36:39]
    v_exp_f32 v53, v53
    v_mfma_f32_16x16x32_bf16 v[40:43], a[148:151], a[4:7], v[40:43]
    buffer_load_dwordx4 v11, s[16:19], s30 offen offset:2064 nt lds
    v_mfma_f32_16x16x32_bf16 v[44:47], a[148:151], a[36:39], v[44:47]
    v_exp_f32 v54, v54
    v_mfma_f32_16x16x32_bf16 v[48:51], a[148:151], a[68:71], v[48:51]
    v_cvt_pk_bf16_f32 v222, v52, v53
    s_waitcnt lgkmcnt(4)
    v_mfma_f32_16x16x32_bf16 v[40:43], a[152:155], a[8:11], v[40:43]
    ds_read_b128 a[176:179], v3 offset:42240
    ds_read_b128 a[180:183], v3 offset:42304
    v_mfma_f32_16x16x32_bf16 v[44:47], a[152:155], a[40:43], v[44:47]
    v_exp_f32 v55, v55
    v_mfma_f32_16x16x32_bf16 v[48:51], a[152:155], a[72:75], v[48:51]
    v_exp_f32 v56, v56
    v_mfma_f32_16x16x32_bf16 v[40:43], a[156:159], a[12:15], v[40:43]
    v_cvt_pk_bf16_f32 v223, v54, v55
    v_mfma_f32_16x16x32_bf16 v[44:47], a[156:159], a[44:47], v[44:47]
    v_exp_f32 v57, v57
    v_mfma_f32_16x16x32_bf16 v[48:51], a[156:159], a[76:79], v[48:51]
    v_cvt_pk_bf16_f32 v226, v56, v57
    s_waitcnt lgkmcnt(4)
    v_mfma_f32_16x16x32_bf16 v[40:43], a[160:163], a[16:19], v[40:43]
    ds_read_b128 a[184:187], v3 offset:42368
    ds_read_b128 a[188:191], v3 offset:42432
    v_mfma_f32_16x16x32_bf16 v[44:47], a[160:163], a[48:51], v[44:47]
    v_exp_f32 v58, v58
    v_mfma_f32_16x16x32_bf16 v[48:51], a[160:163], a[80:83], v[48:51]
    v_exp_f32 v59, v59
    v_mfma_f32_16x16x32_bf16 v[40:43], a[164:167], a[20:23], v[40:43]
    buffer_load_dwordx4 v12, s[16:19], s30 offen offset:3096 nt lds
    v_mfma_f32_16x16x32_bf16 v[44:47], a[164:167], a[52:55], v[44:47]
    v_exp_f32 v60, v60
    v_mfma_f32_16x16x32_bf16 v[48:51], a[164:167], a[84:87], v[48:51]
    v_cvt_pk_bf16_f32 v227, v58, v59
    s_waitcnt lgkmcnt(4)
    v_mfma_f32_16x16x32_bf16 v[40:43], a[168:171], a[24:27], v[40:43]
    ds_read_b128 a[192:195], v3 offset:42496
    ds_read_b128 a[196:199], v3 offset:42560
    v_mfma_f32_16x16x32_bf16 v[44:47], a[168:171], a[56:59], v[44:47]
    v_exp_f32 v61, v61
    v_mfma_f32_16x16x32_bf16 v[48:51], a[168:171], a[88:91], v[48:51]
    v_exp_f32 v62, v62
    v_mfma_f32_16x16x32_bf16 v[40:43], a[172:175], a[28:31], v[40:43]
    v_cvt_pk_bf16_f32 v230, v60, v61
    v_mfma_f32_16x16x32_bf16 v[44:47], a[172:175], a[60:63], v[44:47]
    v_exp_f32 v63, v63
    v_mfma_f32_16x16x32_bf16 v[48:51], a[172:175], a[92:95], v[48:51]
    v_cvt_pk_bf16_f32 v231, v62, v63
    s_waitcnt lgkmcnt(4)
    v_mfma_f32_16x16x32_bf16 a[128:131], a[140:143], v[220:223], a[128:131]
    s_add_u32 m0, s29, 50688
    s_mov_b32 s30, 65664
    v_mfma_f32_16x16x32_bf16 a[132:135], a[140:143], v[224:227], a[132:135]
    v_mfma_f32_16x16x32_bf16 a[136:139], a[140:143], v[228:231], a[136:139]
    v_mfma_f32_16x16x32_bf16 v[52:55], a[176:179], a[0:3], v[28:31]
    ds_read_b128 a[200:203], v3 offset:42624
    ds_read_b128 a[204:207], v3 offset:42688
    v_mfma_f32_16x16x32_bf16 v[56:59], a[176:179], a[32:35], v[32:35]
    v_exp_f32 v40, v40
    v_mfma_f32_16x16x32_bf16 v[60:63], a[176:179], a[64:67], v[36:39]
    v_exp_f32 v41, v41
    v_mfma_f32_16x16x32_bf16 v[52:55], a[180:183], a[4:7], v[52:55]
    v_mfma_f32_16x16x32_bf16 v[56:59], a[180:183], a[36:39], v[56:59]
    v_exp_f32 v42, v42
    v_mfma_f32_16x16x32_bf16 v[60:63], a[180:183], a[68:71], v[60:63]
    v_cvt_pk_bf16_f32 v232, v40, v41
    s_waitcnt lgkmcnt(4)
    v_mfma_f32_16x16x32_bf16 v[52:55], a[184:187], a[8:11], v[52:55]
    ds_read_b128 a[144:147], v4 offset:0
    ds_read_b128 a[148:151], v4 offset:64
    v_mfma_f32_16x16x32_bf16 v[56:59], a[184:187], a[40:43], v[56:59]
    v_exp_f32 v43, v43
    v_mfma_f32_16x16x32_bf16 v[60:63], a[184:187], a[72:75], v[60:63]
    v_exp_f32 v44, v44
    v_mfma_f32_16x16x32_bf16 v[52:55], a[188:191], a[12:15], v[52:55]
    buffer_load_dwordx4 v9, s[16:19], s30 offen offset:0 nt lds
    v_mfma_f32_16x16x32_bf16 v[56:59], a[188:191], a[44:47], v[56:59]
    v_exp_f32 v45, v45
    v_mfma_f32_16x16x32_bf16 v[60:63], a[188:191], a[76:79], v[60:63]
    v_cvt_pk_bf16_f32 v233, v42, v43
    s_waitcnt lgkmcnt(4)
    v_mfma_f32_16x16x32_bf16 v[52:55], a[192:195], a[16:19], v[52:55]
    ds_read_b128 a[152:155], v4 offset:128
    ds_read_b128 a[156:159], v4 offset:192
    v_mfma_f32_16x16x32_bf16 v[56:59], a[192:195], a[48:51], v[56:59]
    v_exp_f32 v46, v46
    v_mfma_f32_16x16x32_bf16 v[60:63], a[192:195], a[80:83], v[60:63]
    v_exp_f32 v47, v47
    v_mfma_f32_16x16x32_bf16 v[52:55], a[196:199], a[20:23], v[52:55]
    buffer_load_dwordx4 v10, s[16:19], s30 offen offset:1032 nt lds
    v_mfma_f32_16x16x32_bf16 v[56:59], a[196:199], a[52:55], v[56:59]
    v_exp_f32 v48, v48
    v_mfma_f32_16x16x32_bf16 v[60:63], a[196:199], a[84:87], v[60:63]
    v_cvt_pk_bf16_f32 v236, v44, v45
    s_waitcnt lgkmcnt(4)
    v_mfma_f32_16x16x32_bf16 v[52:55], a[200:203], a[24:27], v[52:55]
    ds_read_b128 a[160:163], v4 offset:256
    ds_read_b128 a[164:167], v4 offset:320
    v_mfma_f32_16x16x32_bf16 v[56:59], a[200:203], a[56:59], v[56:59]
    v_exp_f32 v49, v49
    v_mfma_f32_16x16x32_bf16 v[60:63], a[200:203], a[88:91], v[60:63]
    v_exp_f32 v50, v50
    v_mfma_f32_16x16x32_bf16 v[52:55], a[204:207], a[28:31], v[52:55]
    v_cvt_pk_bf16_f32 v237, v46, v47
    v_cvt_pk_bf16_f32 v240, v48, v49
    v_mfma_f32_16x16x32_bf16 v[56:59], a[204:207], a[60:63], v[56:59]
    v_exp_f32 v51, v51
    v_mfma_f32_16x16x32_bf16 v[60:63], a[204:207], a[92:95], v[60:63]
    v_cvt_pk_bf16_f32 v241, v50, v51
    s_waitcnt lgkmcnt(4)
    v_mfma_f32_16x16x32_bf16 v[40:43], a[144:147], a[0:3], v[28:31]
    ds_read_b128 a[168:171], v4 offset:384
    ds_read_b128 a[172:175], v4 offset:448
    v_mfma_f32_16x16x32_bf16 v[44:47], a[144:147], a[32:35], v[32:35]
    v_exp_f32 v52, v52
    v_mfma_f32_16x16x32_bf16 v[48:51], a[144:147], a[64:67], v[36:39]
    v_exp_f32 v53, v53
    v_mfma_f32_16x16x32_bf16 v[40:43], a[148:151], a[4:7], v[40:43]
    buffer_load_dwordx4 v11, s[16:19], s30 offen offset:2064 nt lds
    v_mfma_f32_16x16x32_bf16 v[44:47], a[148:151], a[36:39], v[44:47]
    v_exp_f32 v54, v54
    v_mfma_f32_16x16x32_bf16 v[48:51], a[148:151], a[68:71], v[48:51]
    v_cvt_pk_bf16_f32 v234, v52, v53
    s_waitcnt lgkmcnt(4)
    v_mfma_f32_16x16x32_bf16 v[40:43], a[152:155], a[8:11], v[40:43]
    ds_read_b128 a[176:179], v4 offset:8448
    ds_read_b128 a[180:183], v4 offset:8512
    v_mfma_f32_16x16x32_bf16 v[44:47], a[152:155], a[40:43], v[44:47]
    v_exp_f32 v55, v55
    v_mfma_f32_16x16x32_bf16 v[48:51], a[152:155], a[72:75], v[48:51]
    v_exp_f32 v56, v56
    v_mfma_f32_16x16x32_bf16 v[40:43], a[156:159], a[12:15], v[40:43]
    v_cvt_pk_bf16_f32 v235, v54, v55
    v_mfma_f32_16x16x32_bf16 v[44:47], a[156:159], a[44:47], v[44:47]
    v_exp_f32 v57, v57
    v_mfma_f32_16x16x32_bf16 v[48:51], a[156:159], a[76:79], v[48:51]
    v_cvt_pk_bf16_f32 v238, v56, v57
    s_waitcnt lgkmcnt(4)
    v_mfma_f32_16x16x32_bf16 v[40:43], a[160:163], a[16:19], v[40:43]
    ds_read_b128 a[184:187], v4 offset:8576
    ds_read_b128 a[188:191], v4 offset:8640
    v_mfma_f32_16x16x32_bf16 v[44:47], a[160:163], a[48:51], v[44:47]
    v_exp_f32 v58, v58
    v_mfma_f32_16x16x32_bf16 v[48:51], a[160:163], a[80:83], v[48:51]
    v_exp_f32 v59, v59
    v_mfma_f32_16x16x32_bf16 v[40:43], a[164:167], a[20:23], v[40:43]
    buffer_load_dwordx4 v12, s[16:19], s30 offen offset:3096 nt lds
    v_mfma_f32_16x16x32_bf16 v[44:47], a[164:167], a[52:55], v[44:47]
    v_exp_f32 v60, v60
    v_mfma_f32_16x16x32_bf16 v[48:51], a[164:167], a[84:87], v[48:51]
    v_cvt_pk_bf16_f32 v239, v58, v59
    s_waitcnt lgkmcnt(4)
    v_mfma_f32_16x16x32_bf16 v[40:43], a[168:171], a[24:27], v[40:43]
    ds_read_b128 a[192:195], v4 offset:8704
    ds_read_b128 a[196:199], v4 offset:8768
    v_mfma_f32_16x16x32_bf16 v[44:47], a[168:171], a[56:59], v[44:47]
    v_exp_f32 v61, v61
    v_mfma_f32_16x16x32_bf16 v[48:51], a[168:171], a[88:91], v[48:51]
    v_exp_f32 v62, v62
    v_mfma_f32_16x16x32_bf16 v[40:43], a[172:175], a[28:31], v[40:43]
    v_cvt_pk_bf16_f32 v242, v60, v61
    v_mfma_f32_16x16x32_bf16 v[44:47], a[172:175], a[60:63], v[44:47]
    v_exp_f32 v63, v63
    v_mfma_f32_16x16x32_bf16 v[48:51], a[172:175], a[92:95], v[48:51]
    v_cvt_pk_bf16_f32 v243, v62, v63
    s_waitcnt lgkmcnt(4)
    v_mfma_f32_16x16x32_bf16 a[128:131], a[140:143], v[232:235], a[128:131]
    s_add_u32 m0, s29, 67584
    s_mov_b32 s30, 131200
    v_mfma_f32_16x16x32_bf16 a[132:135], a[140:143], v[236:239], a[132:135]
    v_mfma_f32_16x16x32_bf16 a[136:139], a[140:143], v[240:243], a[136:139]
    v_mfma_f32_16x16x32_bf16 v[52:55], a[176:179], a[0:3], v[28:31]
    ds_read_b128 a[200:203], v4 offset:8832
    ds_read_b128 a[204:207], v4 offset:8896
    v_mfma_f32_16x16x32_bf16 v[56:59], a[176:179], a[32:35], v[32:35]
    v_exp_f32 v40, v40
    v_mfma_f32_16x16x32_bf16 v[60:63], a[176:179], a[64:67], v[36:39]
    v_exp_f32 v41, v41
    v_mfma_f32_16x16x32_bf16 v[52:55], a[180:183], a[4:7], v[52:55]
    s_waitcnt vmcnt(16)
    s_barrier
    v_mfma_f32_16x16x32_bf16 v[56:59], a[180:183], a[36:39], v[56:59]
    v_exp_f32 v42, v42
    v_mfma_f32_16x16x32_bf16 v[60:63], a[180:183], a[68:71], v[60:63]
    v_cvt_pk_bf16_f32 v244, v40, v41
    s_waitcnt lgkmcnt(4)
    v_mfma_f32_16x16x32_bf16 v[52:55], a[184:187], a[8:11], v[52:55]
    ds_read_b64_tr_b16 a[96:97], v15 offset:16896
    ds_read_b64_tr_b16 a[98:99], v15 offset:18960
    ds_read_b64_tr_b16 a[100:101], v15 offset:16904
    ds_read_b64_tr_b16 a[102:103], v15 offset:18968
    v_mfma_f32_16x16x32_bf16 v[56:59], a[184:187], a[40:43], v[56:59]
    v_exp_f32 v43, v43
    v_mfma_f32_16x16x32_bf16 v[60:63], a[184:187], a[72:75], v[60:63]
    v_exp_f32 v44, v44
    v_mfma_f32_16x16x32_bf16 v[52:55], a[188:191], a[12:15], v[52:55]
    buffer_load_dwordx4 v9, s[16:19], s30 offen offset:0 nt lds
    v_mfma_f32_16x16x32_bf16 v[56:59], a[188:191], a[44:47], v[56:59]
    v_exp_f32 v45, v45
    v_mfma_f32_16x16x32_bf16 v[60:63], a[188:191], a[76:79], v[60:63]
    v_cvt_pk_bf16_f32 v245, v42, v43
    s_waitcnt lgkmcnt(6)
    v_mfma_f32_16x16x32_bf16 v[52:55], a[192:195], a[16:19], v[52:55]
    ds_read_b64_tr_b16 a[104:105], v18 offset:16896
    ds_read_b64_tr_b16 a[106:107], v18 offset:18960
    ds_read_b64_tr_b16 a[108:109], v18 offset:16904
    ds_read_b64_tr_b16 a[110:111], v18 offset:18968
    v_mfma_f32_16x16x32_bf16 v[56:59], a[192:195], a[48:51], v[56:59]
    v_exp_f32 v46, v46
    v_mfma_f32_16x16x32_bf16 v[60:63], a[192:195], a[80:83], v[60:63]
    v_exp_f32 v47, v47
    v_mfma_f32_16x16x32_bf16 v[52:55], a[196:199], a[20:23], v[52:55]
    buffer_load_dwordx4 v10, s[16:19], s30 offen offset:1032 nt lds
    v_mfma_f32_16x16x32_bf16 v[56:59], a[196:199], a[52:55], v[56:59]
    v_exp_f32 v48, v48
    v_mfma_f32_16x16x32_bf16 v[60:63], a[196:199], a[84:87], v[60:63]
    v_cvt_pk_bf16_f32 v248, v44, v45
    s_waitcnt lgkmcnt(8)
    v_mfma_f32_16x16x32_bf16 v[52:55], a[200:203], a[24:27], v[52:55]
    ds_read_b64_tr_b16 a[112:113], v15 offset:21024
    ds_read_b64_tr_b16 a[114:115], v15 offset:23088
    ds_read_b64_tr_b16 a[116:117], v15 offset:21032
    ds_read_b64_tr_b16 a[118:119], v15 offset:23096
    v_mfma_f32_16x16x32_bf16 v[56:59], a[200:203], a[56:59], v[56:59]
    v_exp_f32 v49, v49
    v_mfma_f32_16x16x32_bf16 v[60:63], a[200:203], a[88:91], v[60:63]
    v_exp_f32 v50, v50
    v_mfma_f32_16x16x32_bf16 v[52:55], a[204:207], a[28:31], v[52:55]
    v_cvt_pk_bf16_f32 v249, v46, v47
    v_cvt_pk_bf16_f32 v252, v48, v49
    v_mfma_f32_16x16x32_bf16 v[56:59], a[204:207], a[60:63], v[56:59]
    v_exp_f32 v51, v51
    v_mfma_f32_16x16x32_bf16 v[60:63], a[204:207], a[92:95], v[60:63]
    v_cvt_pk_bf16_f32 v253, v50, v51
    s_waitcnt lgkmcnt(8)
    v_mfma_f32_16x16x32_bf16 a[144:147], a[96:99], v[64:67], 0
    ds_read_b64_tr_b16 a[120:121], v18 offset:21024
    ds_read_b64_tr_b16 a[122:123], v18 offset:23088
    v_mfma_f32_16x16x32_bf16 a[148:151], a[96:99], v[68:71], 0
    buffer_load_dwordx4 v11, s[16:19], s30 offen offset:2064 nt lds
    v_mfma_f32_16x16x32_bf16 a[152:155], a[96:99], v[72:75], 0
    v_exp_f32 v52, v52
    v_mfma_f32_16x16x32_bf16 a[164:167], a[100:103], v[72:75], 0
    ds_read_b64_tr_b16 a[124:125], v18 offset:21032
    ds_read_b64_tr_b16 a[126:127], v18 offset:23096
    v_mfma_f32_16x16x32_bf16 a[160:163], a[100:103], v[68:71], 0
    v_exp_f32 v53, v53
    v_mfma_f32_16x16x32_bf16 a[156:159], a[100:103], v[64:67], 0
    v_cvt_pk_bf16_f32 v246, v52, v53
    s_waitcnt lgkmcnt(8)
    v_mfma_f32_16x16x32_bf16 a[168:171], a[104:107], v[64:67], 0
    ds_read_b64_tr_b16 a[96:97], v15 offset:25152
    ds_read_b64_tr_b16 a[98:99], v15 offset:27216
    v_mfma_f32_16x16x32_bf16 a[172:175], a[104:107], v[68:71], 0
    buffer_load_dwordx4 v12, s[16:19], s30 offen offset:3096 nt lds
    v_mfma_f32_16x16x32_bf16 a[176:179], a[104:107], v[72:75], 0
    v_exp_f32 v54, v54
    v_mfma_f32_16x16x32_bf16 a[188:191], a[108:111], v[72:75], 0
    ds_read_b64_tr_b16 a[100:101], v15 offset:25160
    ds_read_b64_tr_b16 a[102:103], v15 offset:27224
    v_mfma_f32_16x16x32_bf16 a[184:187], a[108:111], v[68:71], 0
    v_exp_f32 v55, v55
    v_mfma_f32_16x16x32_bf16 a[180:183], a[108:111], v[64:67], 0
    v_cvt_pk_bf16_f32 v247, v54, v55
    s_waitcnt lgkmcnt(8)
    v_mfma_f32_16x16x32_bf16 a[144:147], a[112:115], v[76:79], a[144:147]
    ds_read_b64_tr_b16 a[104:105], v18 offset:25152
    ds_read_b64_tr_b16 a[106:107], v18 offset:27216
    v_mfma_f32_16x16x32_bf16 a[148:151], a[112:115], v[80:83], a[148:151]
    v_exp_f32 v56, v56
    v_mfma_f32_16x16x32_bf16 a[152:155], a[112:115], v[84:87], a[152:155]
    v_exp_f32 v57, v57
    v_mfma_f32_16x16x32_bf16 a[164:167], a[116:119], v[84:87], a[164:167]
    ds_read_b64_tr_b16 a[108:109], v18 offset:25160
    ds_read_b64_tr_b16 a[110:111], v18 offset:27224
    v_mfma_f32_16x16x32_bf16 a[160:163], a[116:119], v[80:83], a[160:163]
    v_exp_f32 v58, v58
    v_mfma_f32_16x16x32_bf16 a[156:159], a[116:119], v[76:79], a[156:159]
    v_cvt_pk_bf16_f32 v250, v56, v57
    s_waitcnt lgkmcnt(8)
    v_mfma_f32_16x16x32_bf16 a[168:171], a[120:123], v[76:79], a[168:171]
    ds_read_b64_tr_b16 a[112:113], v15 offset:29280
    ds_read_b64_tr_b16 a[114:115], v15 offset:31344
    v_mfma_f32_16x16x32_bf16 a[172:175], a[120:123], v[80:83], a[172:175]
    v_exp_f32 v59, v59
    v_mfma_f32_16x16x32_bf16 a[176:179], a[120:123], v[84:87], a[176:179]
    v_cvt_pk_bf16_f32 v251, v58, v59
    v_mfma_f32_16x16x32_bf16 a[188:191], a[124:127], v[84:87], a[188:191]
    ds_read_b64_tr_b16 a[116:117], v15 offset:29288
    ds_read_b64_tr_b16 a[118:119], v15 offset:31352
    v_mfma_f32_16x16x32_bf16 a[184:187], a[124:127], v[80:83], a[184:187]
    v_exp_f32 v60, v60
    v_mfma_f32_16x16x32_bf16 a[180:183], a[124:127], v[76:79], a[180:183]
    s_waitcnt lgkmcnt(8)
    v_mfma_f32_16x16x32_bf16 a[144:147], a[96:99], v[88:91], a[144:147]
    ds_read_b64_tr_b16 a[120:121], v18 offset:29280
    ds_read_b64_tr_b16 a[122:123], v18 offset:31344
    v_mfma_f32_16x16x32_bf16 a[148:151], a[96:99], v[92:95], a[148:151]
    v_exp_f32 v61, v61
    v_mfma_f32_16x16x32_bf16 a[152:155], a[96:99], v[96:99], a[152:155]
    v_exp_f32 v62, v62
    v_mfma_f32_16x16x32_bf16 a[164:167], a[100:103], v[96:99], a[164:167]
    ds_read_b64_tr_b16 a[124:125], v18 offset:29288
    ds_read_b64_tr_b16 a[126:127], v18 offset:31352
    v_mfma_f32_16x16x32_bf16 a[160:163], a[100:103], v[92:95], a[160:163]
    v_exp_f32 v63, v63
    v_mfma_f32_16x16x32_bf16 a[156:159], a[100:103], v[88:91], a[156:159]
    s_add_u32 m0, s29, 84480
    s_waitcnt lgkmcnt(8)
    v_mfma_f32_16x16x32_bf16 a[168:171], a[104:107], v[88:91], a[168:171]
    ds_read_b64_tr_b16 a[96:97], v15 offset:33792
    ds_read_b64_tr_b16 a[98:99], v15 offset:35856
    v_mfma_f32_16x16x32_bf16 a[172:175], a[104:107], v[92:95], a[172:175]
    s_mov_b32 s30, 196736
    v_cvt_pk_bf16_f32 v254, v60, v61
    v_mfma_f32_16x16x32_bf16 a[176:179], a[104:107], v[96:99], a[176:179]
    buffer_load_dwordx4 v9, s[16:19], s30 offen offset:0 nt lds
    v_mfma_f32_16x16x32_bf16 a[188:191], a[108:111], v[96:99], a[188:191]
    ds_read_b64_tr_b16 a[100:101], v15 offset:33800
    ds_read_b64_tr_b16 a[102:103], v15 offset:35864
    v_mfma_f32_16x16x32_bf16 a[184:187], a[108:111], v[92:95], a[184:187]
    v_cvt_pk_bf16_f32 v255, v62, v63
    v_mfma_f32_16x16x32_bf16 a[180:183], a[108:111], v[88:91], a[180:183]
    s_waitcnt lgkmcnt(8)
    v_mfma_f32_16x16x32_bf16 a[144:147], a[112:115], v[100:103], a[144:147]
    ds_read_b64_tr_b16 a[104:105], v18 offset:33792
    ds_read_b64_tr_b16 a[106:107], v18 offset:35856
    v_mfma_f32_16x16x32_bf16 a[148:151], a[112:115], v[104:107], a[148:151]
    buffer_load_dwordx4 v10, s[16:19], s30 offen offset:1032 nt lds
    v_mfma_f32_16x16x32_bf16 a[152:155], a[112:115], v[108:111], a[152:155]
    v_mfma_f32_16x16x32_bf16 a[164:167], a[116:119], v[108:111], a[164:167]
    ds_read_b64_tr_b16 a[108:109], v18 offset:33800
    ds_read_b64_tr_b16 a[110:111], v18 offset:35864
    v_mfma_f32_16x16x32_bf16 a[160:163], a[116:119], v[104:107], a[160:163]
    v_mfma_f32_16x16x32_bf16 a[156:159], a[116:119], v[100:103], a[156:159]
    buffer_load_dwordx4 v11, s[16:19], s30 offen offset:2064 nt lds
    v_mfma_f32_16x16x32_bf16 a[128:131], a[140:143], v[244:247], a[128:131]
    v_mfma_f32_16x16x32_bf16 a[132:135], a[140:143], v[248:251], a[132:135]
    v_mfma_f32_16x16x32_bf16 a[136:139], a[140:143], v[252:255], a[136:139]
    s_waitcnt lgkmcnt(8)
    v_mfma_f32_16x16x32_bf16 a[168:171], a[120:123], v[100:103], a[168:171]
    ds_read_b64_tr_b16 a[112:113], v15 offset:37920
    ds_read_b64_tr_b16 a[114:115], v15 offset:39984
    v_mfma_f32_16x16x32_bf16 a[172:175], a[120:123], v[104:107], a[172:175]
    buffer_load_dwordx4 v12, s[16:19], s30 offen offset:3096 nt lds
    v_mfma_f32_16x16x32_bf16 a[176:179], a[120:123], v[108:111], a[176:179]
    v_mfma_f32_16x16x32_bf16 a[188:191], a[124:127], v[108:111], a[188:191]
    ds_read_b64_tr_b16 a[116:117], v15 offset:37928
    ds_read_b64_tr_b16 a[118:119], v15 offset:39992
    v_mfma_f32_16x16x32_bf16 a[184:187], a[124:127], v[104:107], a[184:187]
    v_accvgpr_read_b32 v28, a128
    v_mfma_f32_16x16x32_bf16 a[180:183], a[124:127], v[100:103], a[180:183]
    v_accvgpr_read_b32 v29, a132
    s_waitcnt lgkmcnt(8)
    v_mfma_f32_16x16x32_bf16 a[144:147], a[96:99], v[112:115], a[144:147]
    ds_read_b64_tr_b16 a[120:121], v18 offset:37920
    ds_read_b64_tr_b16 a[122:123], v18 offset:39984
    v_mfma_f32_16x16x32_bf16 a[148:151], a[96:99], v[116:119], a[148:151]
    v_accvgpr_read_b32 v30, a136
    v_mfma_f32_16x16x32_bf16 a[152:155], a[96:99], v[120:123], a[152:155]
    v_cmp_nge_f32 vcc, s33, v28
    v_mfma_f32_16x16x32_bf16 a[164:167], a[100:103], v[120:123], a[164:167]
    ds_read_b64_tr_b16 a[124:125], v18 offset:37928
    ds_read_b64_tr_b16 a[126:127], v18 offset:39992
    v_mfma_f32_16x16x32_bf16 a[160:163], a[100:103], v[116:119], a[160:163]
    v_cmp_nge_f32 s[46:47], s33, v29
    v_mfma_f32_16x16x32_bf16 a[156:159], a[100:103], v[112:115], a[156:159]
    v_cmp_nge_f32 s[48:49], s33, v30
    s_waitcnt lgkmcnt(8)
    v_mfma_f32_16x16x32_bf16 a[168:171], a[104:107], v[112:115], a[168:171]
    ds_read_b64_tr_b16 a[96:97], v15 offset:42048
    ds_read_b64_tr_b16 a[98:99], v15 offset:44112
    v_mfma_f32_16x16x32_bf16 a[172:175], a[104:107], v[116:119], a[172:175]
    v_rcp_f32 v28, v28
    v_mfma_f32_16x16x32_bf16 a[176:179], a[104:107], v[120:123], a[176:179]
    v_rcp_f32 v29, v29
    v_mfma_f32_16x16x32_bf16 a[188:191], a[108:111], v[120:123], a[188:191]
    ds_read_b64_tr_b16 a[100:101], v15 offset:42056
    ds_read_b64_tr_b16 a[102:103], v15 offset:44120
    v_mfma_f32_16x16x32_bf16 a[184:187], a[108:111], v[116:119], a[184:187]
    v_rcp_f32 v30, v30
    v_mfma_f32_16x16x32_bf16 a[180:183], a[108:111], v[112:115], a[180:183]
    s_or_b64 vcc, vcc, s[46:47]
    s_waitcnt lgkmcnt(8)
    v_mfma_f32_16x16x32_bf16 a[144:147], a[112:115], v[124:127], a[144:147]
    ds_read_b64_tr_b16 a[104:105], v18 offset:42048
    ds_read_b64_tr_b16 a[106:107], v18 offset:44112
    v_mfma_f32_16x16x32_bf16 a[148:151], a[112:115], v[128:131], a[148:151]
    s_or_b64 vcc, vcc, s[48:49]
    v_mfma_f32_16x16x32_bf16 a[152:155], a[112:115], v[132:135], a[152:155]
    s_cmp_lg_u64 vcc, 0
    s_cselect_b32 s46, 1, 0
    v_mfma_f32_16x16x32_bf16 a[164:167], a[116:119], v[132:135], a[164:167]
    ds_read_b64_tr_b16 a[108:109], v18 offset:42056
    ds_read_b64_tr_b16 a[110:111], v18 offset:44120
    v_mfma_f32_16x16x32_bf16 a[160:163], a[116:119], v[128:131], a[160:163]
    v_mov_b32 v19, s46
    v_mfma_f32_16x16x32_bf16 a[156:159], a[116:119], v[124:127], a[156:159]
    v_mov_b32 v20, s50
    s_waitcnt lgkmcnt(8)
    v_mfma_f32_16x16x32_bf16 a[168:171], a[120:123], v[124:127], a[168:171]
    ds_read_b64_tr_b16 a[112:113], v15 offset:46176
    ds_read_b64_tr_b16 a[114:115], v15 offset:48240
    v_mfma_f32_16x16x32_bf16 a[172:175], a[120:123], v[128:131], a[172:175]
    ds_write_b32 v20, v19
    v_mfma_f32_16x16x32_bf16 a[176:179], a[120:123], v[132:135], a[176:179]
    v_mfma_f32_16x16x32_bf16 a[188:191], a[124:127], v[132:135], a[188:191]
    ds_read_b64_tr_b16 a[116:117], v15 offset:46184
    ds_read_b64_tr_b16 a[118:119], v15 offset:48248
    v_mfma_f32_16x16x32_bf16 a[184:187], a[124:127], v[128:131], a[184:187]
    v_mfma_f32_16x16x32_bf16 a[180:183], a[124:127], v[124:127], a[180:183]
    s_waitcnt lgkmcnt(9)
    v_mfma_f32_16x16x32_bf16 a[144:147], a[96:99], v[136:139], a[144:147]
    ds_read_b64_tr_b16 a[120:121], v18 offset:46176
    ds_read_b64_tr_b16 a[122:123], v18 offset:48240
    v_mfma_f32_16x16x32_bf16 a[148:151], a[96:99], v[140:143], a[148:151]
    v_mfma_f32_16x16x32_bf16 a[152:155], a[96:99], v[144:147], a[152:155]
    v_mfma_f32_16x16x32_bf16 a[164:167], a[100:103], v[144:147], a[164:167]
    ds_read_b64_tr_b16 a[124:125], v18 offset:46184
    ds_read_b64_tr_b16 a[126:127], v18 offset:48248
    s_waitcnt lgkmcnt(6)
    v_mfma_f32_16x16x32_bf16 a[160:163], a[100:103], v[140:143], a[160:163]
    s_waitcnt vmcnt(16)
    s_barrier
    v_mfma_f32_16x16x32_bf16 a[156:159], a[100:103], v[136:139], a[156:159]
    s_add_u32 m0, s29, 101376
    s_waitcnt lgkmcnt(9)
    v_mfma_f32_16x16x32_bf16 a[168:171], a[104:107], v[136:139], a[168:171]
    ds_read_b64_tr_b16 a[96:97], v13 offset:0
    ds_read_b64_tr_b16 a[98:99], v13 offset:2064
    v_mfma_f32_16x16x32_bf16 a[172:175], a[104:107], v[140:143], a[172:175]
    s_mov_b32 s30, 256
    v_mov_b32 v21, 152064
    v_mfma_f32_16x16x32_bf16 a[176:179], a[104:107], v[144:147], a[176:179]
    buffer_load_dwordx4 v9, s[16:19], s30 offen offset:0 nt lds
    v_mfma_f32_16x16x32_bf16 a[188:191], a[108:111], v[144:147], a[188:191]
    ds_read_b64_tr_b16 a[100:101], v13 offset:8
    ds_read_b64_tr_b16 a[102:103], v13 offset:2072
    v_mfma_f32_16x16x32_bf16 a[184:187], a[108:111], v[140:143], a[184:187]
    ds_read_b128 v[24:27], v21
    v_mfma_f32_16x16x32_bf16 a[180:183], a[108:111], v[136:139], a[180:183]
    s_waitcnt lgkmcnt(9)
    v_mfma_f32_16x16x32_bf16 a[144:147], a[112:115], v[148:151], a[144:147]
    ds_read_b64_tr_b16 a[104:105], v16 offset:0
    ds_read_b64_tr_b16 a[106:107], v16 offset:2064
    v_mfma_f32_16x16x32_bf16 a[148:151], a[112:115], v[152:155], a[148:151]
    buffer_load_dwordx4 v10, s[16:19], s30 offen offset:1032 nt lds
    v_mfma_f32_16x16x32_bf16 a[152:155], a[112:115], v[156:159], a[152:155]
    v_mfma_f32_16x16x32_bf16 a[164:167], a[116:119], v[156:159], a[164:167]
    ds_read_b64_tr_b16 a[108:109], v16 offset:8
    ds_read_b64_tr_b16 a[110:111], v16 offset:2072
    v_mfma_f32_16x16x32_bf16 a[160:163], a[116:119], v[152:155], a[160:163]
    s_waitcnt lgkmcnt(4)
    v_mfma_f32_16x16x32_bf16 a[156:159], a[116:119], v[148:151], a[156:159]
    v_or_b32 v24, v24, v25
    s_waitcnt lgkmcnt(9)
    v_mfma_f32_16x16x32_bf16 a[168:171], a[120:123], v[148:151], a[168:171]
    ds_read_b64_tr_b16 a[112:113], v13 offset:4128
    ds_read_b64_tr_b16 a[114:115], v13 offset:6192
    v_mfma_f32_16x16x32_bf16 a[172:175], a[120:123], v[152:155], a[172:175]
    buffer_load_dwordx4 v11, s[16:19], s30 offen offset:2064 nt lds
    v_mfma_f32_16x16x32_bf16 a[176:179], a[120:123], v[156:159], a[176:179]
    v_or_b32 v26, v26, v27
    v_mfma_f32_16x16x32_bf16 a[188:191], a[124:127], v[156:159], a[188:191]
    ds_read_b64_tr_b16 a[116:117], v13 offset:4136
    ds_read_b64_tr_b16 a[118:119], v13 offset:6200
    v_mfma_f32_16x16x32_bf16 a[184:187], a[124:127], v[152:155], a[184:187]
    v_or_b32 v24, v24, v26
    v_mfma_f32_16x16x32_bf16 a[180:183], a[124:127], v[148:151], a[180:183]
    s_waitcnt lgkmcnt(9)
    v_mfma_f32_16x16x32_bf16 a[144:147], a[96:99], v[160:163], a[144:147]
    ds_read_b64_tr_b16 a[120:121], v16 offset:4128
    ds_read_b64_tr_b16 a[122:123], v16 offset:6192
    v_mfma_f32_16x16x32_bf16 a[148:151], a[96:99], v[164:167], a[148:151]
    buffer_load_dwordx4 v12, s[16:19], s30 offen offset:3096 nt lds
    v_mfma_f32_16x16x32_bf16 a[152:155], a[96:99], v[168:171], a[152:155]
    v_readfirstlane_b32 s46, v24
    v_mfma_f32_16x16x32_bf16 a[164:167], a[100:103], v[168:171], a[164:167]
    ds_read_b64_tr_b16 a[124:125], v16 offset:4136
    ds_read_b64_tr_b16 a[126:127], v16 offset:6200
    v_mfma_f32_16x16x32_bf16 a[160:163], a[100:103], v[164:167], a[160:163]
    s_andn2_b32 s46, s46, s36
    s_cbranch_scc1 L_fallback
    v_mfma_f32_16x16x32_bf16 a[156:159], a[100:103], v[160:163], a[156:159]
    s_waitcnt lgkmcnt(8)
    v_mfma_f32_16x16x32_bf16 a[168:171], a[104:107], v[160:163], a[168:171]
    ds_read_b64_tr_b16 a[96:97], v13 offset:8256
    ds_read_b64_tr_b16 a[98:99], v13 offset:10320
    v_mfma_f32_16x16x32_bf16 a[172:175], a[104:107], v[164:167], a[172:175]
    v_mfma_f32_16x16x32_bf16 a[176:179], a[104:107], v[168:171], a[176:179]
    v_mfma_f32_16x16x32_bf16 a[188:191], a[108:111], v[168:171], a[188:191]
    ds_read_b64_tr_b16 a[100:101], v13 offset:8264
    ds_read_b64_tr_b16 a[102:103], v13 offset:10328
    v_mfma_f32_16x16x32_bf16 a[184:187], a[108:111], v[164:167], a[184:187]
    v_mfma_f32_16x16x32_bf16 a[180:183], a[108:111], v[160:163], a[180:183]
    s_waitcnt lgkmcnt(8)
    v_mfma_f32_16x16x32_bf16 a[144:147], a[112:115], v[172:175], a[144:147]
    ds_read_b64_tr_b16 a[104:105], v16 offset:8256
    ds_read_b64_tr_b16 a[106:107], v16 offset:10320
    v_mfma_f32_16x16x32_bf16 a[148:151], a[112:115], v[176:179], a[148:151]
    v_mfma_f32_16x16x32_bf16 a[152:155], a[112:115], v[180:183], a[152:155]
    v_mfma_f32_16x16x32_bf16 a[164:167], a[116:119], v[180:183], a[164:167]
    ds_read_b64_tr_b16 a[108:109], v16 offset:8264
    ds_read_b64_tr_b16 a[110:111], v16 offset:10328
    v_mfma_f32_16x16x32_bf16 a[160:163], a[116:119], v[176:179], a[160:163]
    v_mfma_f32_16x16x32_bf16 a[156:159], a[116:119], v[172:175], a[156:159]
    s_waitcnt lgkmcnt(8)
    v_mfma_f32_16x16x32_bf16 a[168:171], a[120:123], v[172:175], a[168:171]
    ds_read_b64_tr_b16 a[112:113], v13 offset:12384
    ds_read_b64_tr_b16 a[114:115], v13 offset:14448
    v_mfma_f32_16x16x32_bf16 a[172:175], a[120:123], v[176:179], a[172:175]
    v_mfma_f32_16x16x32_bf16 a[176:179], a[120:123], v[180:183], a[176:179]
    v_mfma_f32_16x16x32_bf16 a[188:191], a[124:127], v[180:183], a[188:191]
    ds_read_b64_tr_b16 a[116:117], v13 offset:12392
    ds_read_b64_tr_b16 a[118:119], v13 offset:14456
    v_mfma_f32_16x16x32_bf16 a[184:187], a[124:127], v[176:179], a[184:187]
    v_mfma_f32_16x16x32_bf16 a[180:183], a[124:127], v[172:175], a[180:183]
    s_waitcnt lgkmcnt(8)
    v_mfma_f32_16x16x32_bf16 a[144:147], a[96:99], v[184:187], a[144:147]
    ds_read_b64_tr_b16 a[120:121], v16 offset:12384
    ds_read_b64_tr_b16 a[122:123], v16 offset:14448
    v_mfma_f32_16x16x32_bf16 a[148:151], a[96:99], v[188:191], a[148:151]
    v_mfma_f32_16x16x32_bf16 a[152:155], a[96:99], v[192:195], a[152:155]
    v_mfma_f32_16x16x32_bf16 a[164:167], a[100:103], v[192:195], a[164:167]
    ds_read_b64_tr_b16 a[124:125], v16 offset:12392
    ds_read_b64_tr_b16 a[126:127], v16 offset:14456
    v_mfma_f32_16x16x32_bf16 a[160:163], a[100:103], v[188:191], a[160:163]
    v_mfma_f32_16x16x32_bf16 a[156:159], a[100:103], v[184:187], a[156:159]
    s_add_u32 m0, s29, 118272
    s_waitcnt lgkmcnt(8)
    v_mfma_f32_16x16x32_bf16 a[168:171], a[104:107], v[184:187], a[168:171]
    ds_read_b64_tr_b16 a[96:97], v13 offset:16896
    ds_read_b64_tr_b16 a[98:99], v13 offset:18960
    v_mfma_f32_16x16x32_bf16 a[172:175], a[104:107], v[188:191], a[172:175]
    s_mov_b32 s30, 65792
    v_mfma_f32_16x16x32_bf16 a[176:179], a[104:107], v[192:195], a[176:179]
    buffer_load_dwordx4 v9, s[16:19], s30 offen offset:0 nt lds
    v_mfma_f32_16x16x32_bf16 a[188:191], a[108:111], v[192:195], a[188:191]
    ds_read_b64_tr_b16 a[100:101], v13 offset:16904
    ds_read_b64_tr_b16 a[102:103], v13 offset:18968
    v_mfma_f32_16x16x32_bf16 a[184:187], a[108:111], v[188:191], a[184:187]
    v_mfma_f32_16x16x32_bf16 a[180:183], a[108:111], v[184:187], a[180:183]
    s_waitcnt lgkmcnt(8)
    v_mfma_f32_16x16x32_bf16 a[144:147], a[112:115], v[196:199], a[144:147]
    ds_read_b64_tr_b16 a[104:105], v16 offset:16896
    ds_read_b64_tr_b16 a[106:107], v16 offset:18960
    v_mfma_f32_16x16x32_bf16 a[148:151], a[112:115], v[200:203], a[148:151]
    buffer_load_dwordx4 v10, s[16:19], s30 offen offset:1032 nt lds
    v_mfma_f32_16x16x32_bf16 a[152:155], a[112:115], v[204:207], a[152:155]
    v_mfma_f32_16x16x32_bf16 a[164:167], a[116:119], v[204:207], a[164:167]
    ds_read_b64_tr_b16 a[108:109], v16 offset:16904
    ds_read_b64_tr_b16 a[110:111], v16 offset:18968
    v_mfma_f32_16x16x32_bf16 a[160:163], a[116:119], v[200:203], a[160:163]
    v_mfma_f32_16x16x32_bf16 a[156:159], a[116:119], v[196:199], a[156:159]
    s_waitcnt lgkmcnt(8)
    v_mfma_f32_16x16x32_bf16 a[168:171], a[120:123], v[196:199], a[168:171]
    ds_read_b64_tr_b16 a[112:113], v13 offset:21024
    ds_read_b64_tr_b16 a[114:115], v13 offset:23088
    v_mfma_f32_16x16x32_bf16 a[172:175], a[120:123], v[200:203], a[172:175]
    buffer_load_dwordx4 v11, s[16:19], s30 offen offset:2064 nt lds
    v_mfma_f32_16x16x32_bf16 a[176:179], a[120:123], v[204:207], a[176:179]
    v_mfma_f32_16x16x32_bf16 a[188:191], a[124:127], v[204:207], a[188:191]
    ds_read_b64_tr_b16 a[116:117], v13 offset:21032
    ds_read_b64_tr_b16 a[118:119], v13 offset:23096
    v_mfma_f32_16x16x32_bf16 a[184:187], a[124:127], v[200:203], a[184:187]
    v_mfma_f32_16x16x32_bf16 a[180:183], a[124:127], v[196:199], a[180:183]
    s_waitcnt lgkmcnt(8)
    v_mfma_f32_16x16x32_bf16 a[144:147], a[96:99], v[208:211], a[144:147]
    ds_read_b64_tr_b16 a[120:121], v16 offset:21024
    ds_read_b64_tr_b16 a[122:123], v16 offset:23088
    v_mfma_f32_16x16x32_bf16 a[148:151], a[96:99], v[212:215], a[148:151]
    buffer_load_dwordx4 v12, s[16:19], s30 offen offset:3096 nt lds
    v_mfma_f32_16x16x32_bf16 a[152:155], a[96:99], v[216:219], a[152:155]
    v_mfma_f32_16x16x32_bf16 a[164:167], a[100:103], v[216:219], a[164:167]
    ds_read_b64_tr_b16 a[124:125], v16 offset:21032
    ds_read_b64_tr_b16 a[126:127], v16 offset:23096
    v_mfma_f32_16x16x32_bf16 a[160:163], a[100:103], v[212:215], a[160:163]
    v_mfma_f32_16x16x32_bf16 a[156:159], a[100:103], v[208:211], a[156:159]
    s_waitcnt lgkmcnt(8)
    v_mfma_f32_16x16x32_bf16 a[168:171], a[104:107], v[208:211], a[168:171]
    ds_read_b64_tr_b16 a[96:97], v13 offset:25152
    ds_read_b64_tr_b16 a[98:99], v13 offset:27216
    v_mfma_f32_16x16x32_bf16 a[172:175], a[104:107], v[212:215], a[172:175]
    v_mfma_f32_16x16x32_bf16 a[176:179], a[104:107], v[216:219], a[176:179]
    v_mfma_f32_16x16x32_bf16 a[188:191], a[108:111], v[216:219], a[188:191]
    ds_read_b64_tr_b16 a[100:101], v13 offset:25160
    ds_read_b64_tr_b16 a[102:103], v13 offset:27224
    v_mfma_f32_16x16x32_bf16 a[184:187], a[108:111], v[212:215], a[184:187]
    v_mfma_f32_16x16x32_bf16 a[180:183], a[108:111], v[208:211], a[180:183]
    s_waitcnt lgkmcnt(8)
    v_mfma_f32_16x16x32_bf16 a[144:147], a[112:115], v[220:223], a[144:147]
    ds_read_b64_tr_b16 a[104:105], v16 offset:25152
    ds_read_b64_tr_b16 a[106:107], v16 offset:27216
    v_mfma_f32_16x16x32_bf16 a[148:151], a[112:115], v[224:227], a[148:151]
    v_mfma_f32_16x16x32_bf16 a[152:155], a[112:115], v[228:231], a[152:155]
    v_mfma_f32_16x16x32_bf16 a[164:167], a[116:119], v[228:231], a[164:167]
    ds_read_b64_tr_b16 a[108:109], v16 offset:25160
    ds_read_b64_tr_b16 a[110:111], v16 offset:27224
    v_mfma_f32_16x16x32_bf16 a[160:163], a[116:119], v[224:227], a[160:163]
    v_mfma_f32_16x16x32_bf16 a[156:159], a[116:119], v[220:223], a[156:159]
    s_waitcnt lgkmcnt(8)
    v_mfma_f32_16x16x32_bf16 a[168:171], a[120:123], v[220:223], a[168:171]
    ds_read_b64_tr_b16 a[112:113], v13 offset:29280
    ds_read_b64_tr_b16 a[114:115], v13 offset:31344
    v_mfma_f32_16x16x32_bf16 a[172:175], a[120:123], v[224:227], a[172:175]
    v_mfma_f32_16x16x32_bf16 a[176:179], a[120:123], v[228:231], a[176:179]
    v_mfma_f32_16x16x32_bf16 a[188:191], a[124:127], v[228:231], a[188:191]
    ds_read_b64_tr_b16 a[116:117], v13 offset:29288
    ds_read_b64_tr_b16 a[118:119], v13 offset:31352
    v_mfma_f32_16x16x32_bf16 a[184:187], a[124:127], v[224:227], a[184:187]
    v_mfma_f32_16x16x32_bf16 a[180:183], a[124:127], v[220:223], a[180:183]
    s_waitcnt lgkmcnt(8)
    v_mfma_f32_16x16x32_bf16 a[144:147], a[96:99], v[232:235], a[144:147]
    ds_read_b64_tr_b16 a[120:121], v16 offset:29280
    ds_read_b64_tr_b16 a[122:123], v16 offset:31344
    v_mfma_f32_16x16x32_bf16 a[148:151], a[96:99], v[236:239], a[148:151]
    v_mfma_f32_16x16x32_bf16 a[152:155], a[96:99], v[240:243], a[152:155]
    v_mfma_f32_16x16x32_bf16 a[164:167], a[100:103], v[240:243], a[164:167]
    ds_read_b64_tr_b16 a[124:125], v16 offset:29288
    ds_read_b64_tr_b16 a[126:127], v16 offset:31352
    v_mfma_f32_16x16x32_bf16 a[160:163], a[100:103], v[236:239], a[160:163]
    s_waitcnt vmcnt(16)
    s_barrier
    v_mfma_f32_16x16x32_bf16 a[156:159], a[100:103], v[232:235], a[156:159]
    s_add_u32 m0, s29, 135168
    s_waitcnt lgkmcnt(8)
    v_mfma_f32_16x16x32_bf16 a[168:171], a[104:107], v[232:235], a[168:171]
    ds_read_b64_tr_b16 a[96:97], v13 offset:33792
    ds_read_b64_tr_b16 a[98:99], v13 offset:35856
    v_mfma_f32_16x16x32_bf16 a[172:175], a[104:107], v[236:239], a[172:175]
    s_mov_b32 s30, 131328
    v_mfma_f32_16x16x32_bf16 a[176:179], a[104:107], v[240:243], a[176:179]
    buffer_load_dwordx4 v9, s[16:19], s30 offen offset:0 nt lds
    v_mfma_f32_16x16x32_bf16 a[188:191], a[108:111], v[240:243], a[188:191]
    ds_read_b64_tr_b16 a[100:101], v13 offset:33800
    ds_read_b64_tr_b16 a[102:103], v13 offset:35864
    v_mfma_f32_16x16x32_bf16 a[184:187], a[108:111], v[236:239], a[184:187]
    v_mfma_f32_16x16x32_bf16 a[180:183], a[108:111], v[232:235], a[180:183]
    s_waitcnt lgkmcnt(8)
    v_mfma_f32_16x16x32_bf16 a[144:147], a[112:115], v[244:247], a[144:147]
    ds_read_b64_tr_b16 a[104:105], v16 offset:33792
    ds_read_b64_tr_b16 a[106:107], v16 offset:35856
    v_mfma_f32_16x16x32_bf16 a[148:151], a[112:115], v[248:251], a[148:151]
    buffer_load_dwordx4 v10, s[16:19], s30 offen offset:1032 nt lds
    v_mfma_f32_16x16x32_bf16 a[152:155], a[112:115], v[252:255], a[152:155]
    v_mfma_f32_16x16x32_bf16 a[164:167], a[116:119], v[252:255], a[164:167]
    ds_read_b64_tr_b16 a[108:109], v16 offset:33800
    ds_read_b64_tr_b16 a[110:111], v16 offset:35864
    v_mfma_f32_16x16x32_bf16 a[160:163], a[116:119], v[248:251], a[160:163]
    v_mfma_f32_16x16x32_bf16 a[156:159], a[116:119], v[244:247], a[156:159]
    s_waitcnt lgkmcnt(8)
    v_mfma_f32_16x16x32_bf16 a[168:171], a[120:123], v[244:247], a[168:171]
    ds_read_b64_tr_b16 a[112:113], v13 offset:37920
    ds_read_b64_tr_b16 a[114:115], v13 offset:39984
    v_mfma_f32_16x16x32_bf16 a[172:175], a[120:123], v[248:251], a[172:175]
    buffer_load_dwordx4 v11, s[16:19], s30 offen offset:2064 nt lds
    v_mfma_f32_16x16x32_bf16 a[176:179], a[120:123], v[252:255], a[176:179]
    v_mfma_f32_16x16x32_bf16 a[188:191], a[124:127], v[252:255], a[188:191]
    ds_read_b64_tr_b16 a[116:117], v13 offset:37928
    ds_read_b64_tr_b16 a[118:119], v13 offset:39992
    v_mfma_f32_16x16x32_bf16 a[184:187], a[124:127], v[248:251], a[184:187]
    v_mfma_f32_16x16x32_bf16 a[180:183], a[124:127], v[244:247], a[180:183]
    s_waitcnt lgkmcnt(8)
    v_mfma_f32_16x16x32_bf16 a[192:195], a[96:99], v[64:67], 0
    ds_read_b64_tr_b16 a[120:121], v16 offset:37920
    ds_read_b64_tr_b16 a[122:123], v16 offset:39984
    v_mfma_f32_16x16x32_bf16 a[196:199], a[96:99], v[68:71], 0
    buffer_load_dwordx4 v12, s[16:19], s30 offen offset:3096 nt lds
    v_mfma_f32_16x16x32_bf16 a[200:203], a[96:99], v[72:75], 0
    v_mfma_f32_16x16x32_bf16 a[212:215], a[100:103], v[72:75], 0
    ds_read_b64_tr_b16 a[124:125], v16 offset:37928
    ds_read_b64_tr_b16 a[126:127], v16 offset:39992
    v_mfma_f32_16x16x32_bf16 a[208:211], a[100:103], v[68:71], 0
    v_accvgpr_read_b32 v40, a144
    v_accvgpr_read_b32 v41, a145
    v_mfma_f32_16x16x32_bf16 a[204:207], a[100:103], v[64:67], 0
    v_accvgpr_read_b32 v42, a146
    s_waitcnt lgkmcnt(8)
    v_mfma_f32_16x16x32_bf16 a[216:219], a[104:107], v[64:67], 0
    ds_read_b64_tr_b16 a[96:97], v13 offset:42048
    ds_read_b64_tr_b16 a[98:99], v13 offset:44112
    v_mfma_f32_16x16x32_bf16 a[220:223], a[104:107], v[68:71], 0
    v_accvgpr_read_b32 v43, a147
    v_accvgpr_read_b32 v44, a156
    v_mfma_f32_16x16x32_bf16 a[224:227], a[104:107], v[72:75], 0
    v_accvgpr_read_b32 v45, a157
    v_accvgpr_read_b32 v46, a158
    v_mfma_f32_16x16x32_bf16 a[236:239], a[108:111], v[72:75], 0
    ds_read_b64_tr_b16 a[100:101], v13 offset:42056
    ds_read_b64_tr_b16 a[102:103], v13 offset:44120
    v_mfma_f32_16x16x32_bf16 a[232:235], a[108:111], v[68:71], 0
    v_accvgpr_read_b32 v47, a159
    v_mul_f32 v40, v28, v40
    v_mfma_f32_16x16x32_bf16 a[228:231], a[108:111], v[64:67], 0
    v_mul_f32 v41, v28, v41
    s_waitcnt lgkmcnt(8)
    v_mfma_f32_16x16x32_bf16 a[192:195], a[112:115], v[76:79], a[192:195]
    ds_read_b64_tr_b16 a[104:105], v16 offset:42048
    ds_read_b64_tr_b16 a[106:107], v16 offset:44112
    v_mfma_f32_16x16x32_bf16 a[196:199], a[112:115], v[80:83], a[196:199]
    v_mul_f32 v42, v28, v42
    v_mul_f32 v43, v28, v43
    v_mfma_f32_16x16x32_bf16 a[200:203], a[112:115], v[84:87], a[200:203]
    v_mul_f32 v44, v28, v44
    v_mul_f32 v45, v28, v45
    v_mfma_f32_16x16x32_bf16 a[212:215], a[116:119], v[84:87], a[212:215]
    ds_read_b64_tr_b16 a[108:109], v16 offset:42056
    ds_read_b64_tr_b16 a[110:111], v16 offset:44120
    v_mfma_f32_16x16x32_bf16 a[208:211], a[116:119], v[80:83], a[208:211]
    v_mul_f32 v46, v28, v46
    v_mul_f32 v47, v28, v47
    v_mfma_f32_16x16x32_bf16 a[204:207], a[116:119], v[76:79], a[204:207]
    v_cvt_pk_bf16_f32 v48, v40, v41
    s_waitcnt lgkmcnt(8)
    v_mfma_f32_16x16x32_bf16 a[216:219], a[120:123], v[76:79], a[216:219]
    ds_read_b64_tr_b16 a[112:113], v13 offset:46176
    ds_read_b64_tr_b16 a[114:115], v13 offset:48240
    v_mfma_f32_16x16x32_bf16 a[220:223], a[120:123], v[80:83], a[220:223]
    v_cvt_pk_bf16_f32 v49, v42, v43
    v_cvt_pk_bf16_f32 v50, v44, v45
    v_mfma_f32_16x16x32_bf16 a[224:227], a[120:123], v[84:87], a[224:227]
    v_cvt_pk_bf16_f32 v51, v46, v47
    v_accvgpr_write_b32 a144, v48
    v_mfma_f32_16x16x32_bf16 a[236:239], a[124:127], v[84:87], a[236:239]
    ds_read_b64_tr_b16 a[116:117], v13 offset:46184
    ds_read_b64_tr_b16 a[118:119], v13 offset:48248
    v_mfma_f32_16x16x32_bf16 a[232:235], a[124:127], v[80:83], a[232:235]
    v_accvgpr_write_b32 a145, v49
    v_accvgpr_write_b32 a146, v50
    v_mfma_f32_16x16x32_bf16 a[228:231], a[124:127], v[76:79], a[228:231]
    v_accvgpr_write_b32 a147, v51
    s_waitcnt lgkmcnt(8)
    v_mfma_f32_16x16x32_bf16 a[192:195], a[96:99], v[88:91], a[192:195]
    ds_read_b64_tr_b16 a[120:121], v16 offset:46176
    ds_read_b64_tr_b16 a[122:123], v16 offset:48240
    v_mfma_f32_16x16x32_bf16 a[196:199], a[96:99], v[92:95], a[196:199]
    v_accvgpr_read_b32 v40, a168
    v_accvgpr_read_b32 v41, a169
    v_mfma_f32_16x16x32_bf16 a[200:203], a[96:99], v[96:99], a[200:203]
    v_accvgpr_read_b32 v42, a170
    v_accvgpr_read_b32 v43, a171
    v_mfma_f32_16x16x32_bf16 a[212:215], a[100:103], v[96:99], a[212:215]
    ds_read_b64_tr_b16 a[124:125], v16 offset:46184
    ds_read_b64_tr_b16 a[126:127], v16 offset:48248
    v_mfma_f32_16x16x32_bf16 a[208:211], a[100:103], v[92:95], a[208:211]
    v_accvgpr_read_b32 v44, a180
    v_accvgpr_read_b32 v45, a181
    v_mfma_f32_16x16x32_bf16 a[204:207], a[100:103], v[88:91], a[204:207]
    s_add_u32 m0, s29, 0
    s_waitcnt lgkmcnt(8)
    v_mfma_f32_16x16x32_bf16 a[216:219], a[104:107], v[88:91], a[216:219]
    ds_read_b64_tr_b16 a[96:97], v14 offset:0
    ds_read_b64_tr_b16 a[98:99], v14 offset:2064
    v_mfma_f32_16x16x32_bf16 a[220:223], a[104:107], v[92:95], a[220:223]
    s_mov_b32 s30, 196864
    v_accvgpr_read_b32 v46, a182
    v_mfma_f32_16x16x32_bf16 a[224:227], a[104:107], v[96:99], a[224:227]
    buffer_load_dwordx4 v9, s[16:19], s30 offen offset:0 nt lds
    v_mfma_f32_16x16x32_bf16 a[236:239], a[108:111], v[96:99], a[236:239]
    ds_read_b64_tr_b16 a[100:101], v14 offset:8
    ds_read_b64_tr_b16 a[102:103], v14 offset:2072
    v_mfma_f32_16x16x32_bf16 a[232:235], a[108:111], v[92:95], a[232:235]
    v_accvgpr_read_b32 v47, a183
    v_mul_f32 v40, v28, v40
    v_mfma_f32_16x16x32_bf16 a[228:231], a[108:111], v[88:91], a[228:231]
    v_mul_f32 v41, v28, v41
    s_waitcnt lgkmcnt(8)
    v_mfma_f32_16x16x32_bf16 a[192:195], a[112:115], v[100:103], a[192:195]
    ds_read_b64_tr_b16 a[104:105], v17 offset:0
    ds_read_b64_tr_b16 a[106:107], v17 offset:2064
    v_mfma_f32_16x16x32_bf16 a[196:199], a[112:115], v[104:107], a[196:199]
    buffer_load_dwordx4 v10, s[16:19], s30 offen offset:1032 nt lds
    v_mfma_f32_16x16x32_bf16 a[200:203], a[112:115], v[108:111], a[200:203]
    v_mul_f32 v42, v28, v42
    v_mul_f32 v43, v28, v43
    v_mfma_f32_16x16x32_bf16 a[212:215], a[116:119], v[108:111], a[212:215]
    ds_read_b64_tr_b16 a[108:109], v17 offset:8
    ds_read_b64_tr_b16 a[110:111], v17 offset:2072
    v_mfma_f32_16x16x32_bf16 a[208:211], a[116:119], v[104:107], a[208:211]
    v_mul_f32 v44, v28, v44
    v_mul_f32 v45, v28, v45
    v_mfma_f32_16x16x32_bf16 a[204:207], a[116:119], v[100:103], a[204:207]
    v_mul_f32 v46, v28, v46
    s_waitcnt lgkmcnt(8)
    v_mfma_f32_16x16x32_bf16 a[216:219], a[120:123], v[100:103], a[216:219]
    ds_read_b64_tr_b16 a[112:113], v14 offset:4128
    ds_read_b64_tr_b16 a[114:115], v14 offset:6192
    v_mfma_f32_16x16x32_bf16 a[220:223], a[120:123], v[104:107], a[220:223]
    buffer_load_dwordx4 v11, s[16:19], s30 offen offset:2064 nt lds
    v_mfma_f32_16x16x32_bf16 a[224:227], a[120:123], v[108:111], a[224:227]
    v_mul_f32 v47, v28, v47
    v_cvt_pk_bf16_f32 v52, v40, v41
    v_mfma_f32_16x16x32_bf16 a[236:239], a[124:127], v[108:111], a[236:239]
    ds_read_b64_tr_b16 a[116:117], v14 offset:4136
    ds_read_b64_tr_b16 a[118:119], v14 offset:6200
    v_mfma_f32_16x16x32_bf16 a[232:235], a[124:127], v[104:107], a[232:235]
    v_cvt_pk_bf16_f32 v53, v42, v43
    v_cvt_pk_bf16_f32 v54, v44, v45
    v_mfma_f32_16x16x32_bf16 a[228:231], a[124:127], v[100:103], a[228:231]
    v_cvt_pk_bf16_f32 v55, v46, v47
    s_waitcnt lgkmcnt(8)
    v_mfma_f32_16x16x32_bf16 a[192:195], a[96:99], v[112:115], a[192:195]
    ds_read_b64_tr_b16 a[120:121], v17 offset:4128
    ds_read_b64_tr_b16 a[122:123], v17 offset:6192
    v_mfma_f32_16x16x32_bf16 a[196:199], a[96:99], v[116:119], a[196:199]
    buffer_load_dwordx4 v12, s[16:19], s30 offen offset:3096 nt lds
    v_mfma_f32_16x16x32_bf16 a[200:203], a[96:99], v[120:123], a[200:203]
    v_accvgpr_write_b32 a156, v52
    v_accvgpr_write_b32 a157, v53
    v_mfma_f32_16x16x32_bf16 a[212:215], a[100:103], v[120:123], a[212:215]
    ds_read_b64_tr_b16 a[124:125], v17 offset:4136
    ds_read_b64_tr_b16 a[126:127], v17 offset:6200
    v_mfma_f32_16x16x32_bf16 a[208:211], a[100:103], v[116:119], a[208:211]
    v_accvgpr_write_b32 a158, v54
    v_accvgpr_write_b32 a159, v55
    v_mfma_f32_16x16x32_bf16 a[204:207], a[100:103], v[112:115], a[204:207]
    v_accvgpr_read_b32 v40, a148
    s_waitcnt lgkmcnt(8)
    v_mfma_f32_16x16x32_bf16 a[216:219], a[104:107], v[112:115], a[216:219]
    ds_read_b64_tr_b16 a[96:97], v14 offset:8256
    ds_read_b64_tr_b16 a[98:99], v14 offset:10320
    v_mfma_f32_16x16x32_bf16 a[220:223], a[104:107], v[116:119], a[220:223]
    v_accvgpr_read_b32 v41, a149
    v_accvgpr_read_b32 v42, a150
    v_mfma_f32_16x16x32_bf16 a[224:227], a[104:107], v[120:123], a[224:227]
    v_accvgpr_read_b32 v43, a151
    v_accvgpr_read_b32 v44, a160
    v_mfma_f32_16x16x32_bf16 a[236:239], a[108:111], v[120:123], a[236:239]
    ds_read_b64_tr_b16 a[100:101], v14 offset:8264
    ds_read_b64_tr_b16 a[102:103], v14 offset:10328
    v_mfma_f32_16x16x32_bf16 a[232:235], a[108:111], v[116:119], a[232:235]
    v_accvgpr_read_b32 v45, a161
    v_accvgpr_read_b32 v46, a162
    v_mfma_f32_16x16x32_bf16 a[228:231], a[108:111], v[112:115], a[228:231]
    v_accvgpr_read_b32 v47, a163
    s_waitcnt lgkmcnt(8)
    v_mfma_f32_16x16x32_bf16 a[192:195], a[112:115], v[124:127], a[192:195]
    ds_read_b64_tr_b16 a[104:105], v17 offset:8256
    ds_read_b64_tr_b16 a[106:107], v17 offset:10320
    v_mfma_f32_16x16x32_bf16 a[196:199], a[112:115], v[128:131], a[196:199]
    v_mul_f32 v40, v29, v40
    v_mul_f32 v41, v29, v41
    v_mfma_f32_16x16x32_bf16 a[200:203], a[112:115], v[132:135], a[200:203]
    v_mul_f32 v42, v29, v42
    v_mul_f32 v43, v29, v43
    v_mfma_f32_16x16x32_bf16 a[212:215], a[116:119], v[132:135], a[212:215]
    ds_read_b64_tr_b16 a[108:109], v17 offset:8264
    ds_read_b64_tr_b16 a[110:111], v17 offset:10328
    v_mfma_f32_16x16x32_bf16 a[208:211], a[116:119], v[128:131], a[208:211]
    v_mul_f32 v44, v29, v44
    v_mul_f32 v45, v29, v45
    v_mfma_f32_16x16x32_bf16 a[204:207], a[116:119], v[124:127], a[204:207]
    v_mul_f32 v46, v29, v46
    s_waitcnt lgkmcnt(8)
    v_mfma_f32_16x16x32_bf16 a[216:219], a[120:123], v[124:127], a[216:219]
    ds_read_b64_tr_b16 a[112:113], v14 offset:12384
    ds_read_b64_tr_b16 a[114:115], v14 offset:14448
    v_mfma_f32_16x16x32_bf16 a[220:223], a[120:123], v[128:131], a[220:223]
    v_mul_f32 v47, v29, v47
    v_cvt_pk_bf16_f32 v48, v40, v41
    v_mfma_f32_16x16x32_bf16 a[224:227], a[120:123], v[132:135], a[224:227]
    v_cvt_pk_bf16_f32 v49, v42, v43
    v_cvt_pk_bf16_f32 v50, v44, v45
    v_mfma_f32_16x16x32_bf16 a[236:239], a[124:127], v[132:135], a[236:239]
    ds_read_b64_tr_b16 a[116:117], v14 offset:12392
    ds_read_b64_tr_b16 a[118:119], v14 offset:14456
    v_mfma_f32_16x16x32_bf16 a[232:235], a[124:127], v[128:131], a[232:235]
    v_cvt_pk_bf16_f32 v51, v46, v47
    v_accvgpr_write_b32 a148, v48
    v_mfma_f32_16x16x32_bf16 a[228:231], a[124:127], v[124:127], a[228:231]
    v_accvgpr_write_b32 a149, v49
    s_waitcnt lgkmcnt(8)
    v_mfma_f32_16x16x32_bf16 a[192:195], a[96:99], v[136:139], a[192:195]
    ds_read_b64_tr_b16 a[120:121], v17 offset:12384
    ds_read_b64_tr_b16 a[122:123], v17 offset:14448
    v_mfma_f32_16x16x32_bf16 a[196:199], a[96:99], v[140:143], a[196:199]
    v_accvgpr_write_b32 a150, v50
    v_accvgpr_write_b32 a151, v51
    v_mfma_f32_16x16x32_bf16 a[200:203], a[96:99], v[144:147], a[200:203]
    v_accvgpr_read_b32 v40, a172
    v_accvgpr_read_b32 v41, a173
    v_mfma_f32_16x16x32_bf16 a[212:215], a[100:103], v[144:147], a[212:215]
    ds_read_b64_tr_b16 a[124:125], v17 offset:12392
    ds_read_b64_tr_b16 a[126:127], v17 offset:14456
    v_mfma_f32_16x16x32_bf16 a[208:211], a[100:103], v[140:143], a[208:211]
    s_waitcnt vmcnt(16)
    s_barrier
    v_mfma_f32_16x16x32_bf16 a[204:207], a[100:103], v[136:139], a[204:207]
    s_add_u32 m0, s29, 16896
    s_waitcnt lgkmcnt(8)
    v_mfma_f32_16x16x32_bf16 a[216:219], a[104:107], v[136:139], a[216:219]
    ds_read_b64_tr_b16 a[96:97], v14 offset:16896
    ds_read_b64_tr_b16 a[98:99], v14 offset:18960
    v_mfma_f32_16x16x32_bf16 a[220:223], a[104:107], v[140:143], a[220:223]
    s_mov_b32 s30, 384
    v_accvgpr_read_b32 v42, a174
    v_mfma_f32_16x16x32_bf16 a[224:227], a[104:107], v[144:147], a[224:227]
    buffer_load_dwordx4 v9, s[16:19], s30 offen offset:0 nt lds
    v_mfma_f32_16x16x32_bf16 a[236:239], a[108:111], v[144:147], a[236:239]
    ds_read_b64_tr_b16 a[100:101], v14 offset:16904
    ds_read_b64_tr_b16 a[102:103], v14 offset:18968
    v_mfma_f32_16x16x32_bf16 a[232:235], a[108:111], v[140:143], a[232:235]
    v_accvgpr_read_b32 v43, a175
    v_accvgpr_read_b32 v44, a184
    v_mfma_f32_16x16x32_bf16 a[228:231], a[108:111], v[136:139], a[228:231]
    v_accvgpr_read_b32 v45, a185
    s_waitcnt lgkmcnt(8)
    v_mfma_f32_16x16x32_bf16 a[192:195], a[112:115], v[148:151], a[192:195]
    ds_read_b64_tr_b16 a[104:105], v17 offset:16896
    ds_read_b64_tr_b16 a[106:107], v17 offset:18960
    v_mfma_f32_16x16x32_bf16 a[196:199], a[112:115], v[152:155], a[196:199]
    buffer_load_dwordx4 v10, s[16:19], s30 offen offset:1032 nt lds
    v_mfma_f32_16x16x32_bf16 a[200:203], a[112:115], v[156:159], a[200:203]
    v_accvgpr_read_b32 v46, a186
    v_accvgpr_read_b32 v47, a187
    v_mfma_f32_16x16x32_bf16 a[212:215], a[116:119], v[156:159], a[212:215]
    ds_read_b64_tr_b16 a[108:109], v17 offset:16904
    ds_read_b64_tr_b16 a[110:111], v17 offset:18968
    v_mfma_f32_16x16x32_bf16 a[208:211], a[116:119], v[152:155], a[208:211]
    v_mul_f32 v40, v29, v40
    v_mul_f32 v41, v29, v41
    v_mfma_f32_16x16x32_bf16 a[204:207], a[116:119], v[148:151], a[204:207]
    v_mul_f32 v42, v29, v42
    s_waitcnt lgkmcnt(8)
    v_mfma_f32_16x16x32_bf16 a[216:219], a[120:123], v[148:151], a[216:219]
    ds_read_b64_tr_b16 a[112:113], v14 offset:21024
    ds_read_b64_tr_b16 a[114:115], v14 offset:23088
    v_mfma_f32_16x16x32_bf16 a[220:223], a[120:123], v[152:155], a[220:223]
    buffer_load_dwordx4 v11, s[16:19], s30 offen offset:2064 nt lds
    v_mfma_f32_16x16x32_bf16 a[224:227], a[120:123], v[156:159], a[224:227]
    v_mul_f32 v43, v29, v43
    v_mul_f32 v44, v29, v44
    v_mfma_f32_16x16x32_bf16 a[236:239], a[124:127], v[156:159], a[236:239]
    ds_read_b64_tr_b16 a[116:117], v14 offset:21032
    ds_read_b64_tr_b16 a[118:119], v14 offset:23096
    v_mfma_f32_16x16x32_bf16 a[232:235], a[124:127], v[152:155], a[232:235]
    v_mul_f32 v45, v29, v45
    v_mul_f32 v46, v29, v46
    v_mfma_f32_16x16x32_bf16 a[228:231], a[124:127], v[148:151], a[228:231]
    v_mul_f32 v47, v29, v47
    s_waitcnt lgkmcnt(8)
    v_mfma_f32_16x16x32_bf16 a[192:195], a[96:99], v[160:163], a[192:195]
    ds_read_b64_tr_b16 a[120:121], v17 offset:21024
    ds_read_b64_tr_b16 a[122:123], v17 offset:23088
    v_mfma_f32_16x16x32_bf16 a[196:199], a[96:99], v[164:167], a[196:199]
    buffer_load_dwordx4 v12, s[16:19], s30 offen offset:3096 nt lds
    v_mfma_f32_16x16x32_bf16 a[200:203], a[96:99], v[168:171], a[200:203]
    v_cvt_pk_bf16_f32 v52, v40, v41
    v_cvt_pk_bf16_f32 v53, v42, v43
    v_mfma_f32_16x16x32_bf16 a[212:215], a[100:103], v[168:171], a[212:215]
    ds_read_b64_tr_b16 a[124:125], v17 offset:21032
    ds_read_b64_tr_b16 a[126:127], v17 offset:23096
    v_mfma_f32_16x16x32_bf16 a[208:211], a[100:103], v[164:167], a[208:211]
    v_cvt_pk_bf16_f32 v54, v44, v45
    v_cvt_pk_bf16_f32 v55, v46, v47
    v_mfma_f32_16x16x32_bf16 a[204:207], a[100:103], v[160:163], a[204:207]
    v_accvgpr_write_b32 a160, v52
    s_waitcnt lgkmcnt(8)
    v_mfma_f32_16x16x32_bf16 a[216:219], a[104:107], v[160:163], a[216:219]
    ds_read_b64_tr_b16 a[96:97], v14 offset:25152
    ds_read_b64_tr_b16 a[98:99], v14 offset:27216
    v_mfma_f32_16x16x32_bf16 a[220:223], a[104:107], v[164:167], a[220:223]
    v_accvgpr_write_b32 a161, v53
    v_accvgpr_write_b32 a162, v54
    v_mfma_f32_16x16x32_bf16 a[224:227], a[104:107], v[168:171], a[224:227]
    v_accvgpr_write_b32 a163, v55
    v_mfma_f32_16x16x32_bf16 a[236:239], a[108:111], v[168:171], a[236:239]
    ds_read_b64_tr_b16 a[100:101], v14 offset:25160
    ds_read_b64_tr_b16 a[102:103], v14 offset:27224
    v_mfma_f32_16x16x32_bf16 a[232:235], a[108:111], v[164:167], a[232:235]
    v_accvgpr_read_b32 v40, a152
    v_accvgpr_read_b32 v41, a153
    v_mfma_f32_16x16x32_bf16 a[228:231], a[108:111], v[160:163], a[228:231]
    v_accvgpr_read_b32 v42, a154
    s_waitcnt lgkmcnt(8)
    v_mfma_f32_16x16x32_bf16 a[192:195], a[112:115], v[172:175], a[192:195]
    ds_read_b64_tr_b16 a[104:105], v17 offset:25152
    ds_read_b64_tr_b16 a[106:107], v17 offset:27216
    v_mfma_f32_16x16x32_bf16 a[196:199], a[112:115], v[176:179], a[196:199]
    v_accvgpr_read_b32 v43, a155
    v_accvgpr_read_b32 v44, a164
    v_mfma_f32_16x16x32_bf16 a[200:203], a[112:115], v[180:183], a[200:203]
    v_accvgpr_read_b32 v45, a165
    v_accvgpr_read_b32 v46, a166
    v_mfma_f32_16x16x32_bf16 a[212:215], a[116:119], v[180:183], a[212:215]
    ds_read_b64_tr_b16 a[108:109], v17 offset:25160
    ds_read_b64_tr_b16 a[110:111], v17 offset:27224
    v_mfma_f32_16x16x32_bf16 a[208:211], a[116:119], v[176:179], a[208:211]
    v_accvgpr_read_b32 v47, a167
    v_mul_f32 v40, v30, v40
    v_mfma_f32_16x16x32_bf16 a[204:207], a[116:119], v[172:175], a[204:207]
    v_mul_f32 v41, v30, v41
    s_waitcnt lgkmcnt(8)
    v_mfma_f32_16x16x32_bf16 a[216:219], a[120:123], v[172:175], a[216:219]
    ds_read_b64_tr_b16 a[112:113], v14 offset:29280
    ds_read_b64_tr_b16 a[114:115], v14 offset:31344
    v_mfma_f32_16x16x32_bf16 a[220:223], a[120:123], v[176:179], a[220:223]
    v_mul_f32 v42, v30, v42
    v_mul_f32 v43, v30, v43
    v_mfma_f32_16x16x32_bf16 a[224:227], a[120:123], v[180:183], a[224:227]
    v_mul_f32 v44, v30, v44
    v_mul_f32 v45, v30, v45
    v_mfma_f32_16x16x32_bf16 a[236:239], a[124:127], v[180:183], a[236:239]
    ds_read_b64_tr_b16 a[116:117], v14 offset:29288
    ds_read_b64_tr_b16 a[118:119], v14 offset:31352
    v_mfma_f32_16x16x32_bf16 a[232:235], a[124:127], v[176:179], a[232:235]
    v_mul_f32 v46, v30, v46
    v_mul_f32 v47, v30, v47
    v_mfma_f32_16x16x32_bf16 a[228:231], a[124:127], v[172:175], a[228:231]
    v_cvt_pk_bf16_f32 v48, v40, v41
    s_waitcnt lgkmcnt(8)
    v_mfma_f32_16x16x32_bf16 a[192:195], a[96:99], v[184:187], a[192:195]
    ds_read_b64_tr_b16 a[120:121], v17 offset:29280
    ds_read_b64_tr_b16 a[122:123], v17 offset:31344
    v_mfma_f32_16x16x32_bf16 a[196:199], a[96:99], v[188:191], a[196:199]
    v_cvt_pk_bf16_f32 v49, v42, v43
    v_cvt_pk_bf16_f32 v50, v44, v45
    v_mfma_f32_16x16x32_bf16 a[200:203], a[96:99], v[192:195], a[200:203]
    v_cvt_pk_bf16_f32 v51, v46, v47
    v_accvgpr_write_b32 a152, v48
    v_mfma_f32_16x16x32_bf16 a[212:215], a[100:103], v[192:195], a[212:215]
    ds_read_b64_tr_b16 a[124:125], v17 offset:29288
    ds_read_b64_tr_b16 a[126:127], v17 offset:31352
    v_mfma_f32_16x16x32_bf16 a[208:211], a[100:103], v[188:191], a[208:211]
    v_accvgpr_write_b32 a153, v49
    v_accvgpr_write_b32 a154, v50
    v_mfma_f32_16x16x32_bf16 a[204:207], a[100:103], v[184:187], a[204:207]
    s_add_u32 m0, s29, 33792
    s_waitcnt lgkmcnt(8)
    v_mfma_f32_16x16x32_bf16 a[216:219], a[104:107], v[184:187], a[216:219]
    ds_read_b64_tr_b16 a[96:97], v14 offset:33792
    ds_read_b64_tr_b16 a[98:99], v14 offset:35856
    v_mfma_f32_16x16x32_bf16 a[220:223], a[104:107], v[188:191], a[220:223]
    s_mov_b32 s30, 65920
    v_accvgpr_write_b32 a155, v51
    v_mfma_f32_16x16x32_bf16 a[224:227], a[104:107], v[192:195], a[224:227]
    buffer_load_dwordx4 v9, s[16:19], s30 offen offset:0 nt lds
    v_mfma_f32_16x16x32_bf16 a[236:239], a[108:111], v[192:195], a[236:239]
    ds_read_b64_tr_b16 a[100:101], v14 offset:33800
    ds_read_b64_tr_b16 a[102:103], v14 offset:35864
    v_mfma_f32_16x16x32_bf16 a[232:235], a[108:111], v[188:191], a[232:235]
    v_accvgpr_read_b32 v40, a176
    v_accvgpr_read_b32 v41, a177
    v_mfma_f32_16x16x32_bf16 a[228:231], a[108:111], v[184:187], a[228:231]
    v_accvgpr_read_b32 v42, a178
    s_waitcnt lgkmcnt(8)
    v_mfma_f32_16x16x32_bf16 a[192:195], a[112:115], v[196:199], a[192:195]
    ds_read_b64_tr_b16 a[104:105], v17 offset:33792
    ds_read_b64_tr_b16 a[106:107], v17 offset:35856
    v_mfma_f32_16x16x32_bf16 a[196:199], a[112:115], v[200:203], a[196:199]
    buffer_load_dwordx4 v10, s[16:19], s30 offen offset:1032 nt lds
    v_mfma_f32_16x16x32_bf16 a[200:203], a[112:115], v[204:207], a[200:203]
    v_accvgpr_read_b32 v43, a179
    v_accvgpr_read_b32 v44, a188
    v_mfma_f32_16x16x32_bf16 a[212:215], a[116:119], v[204:207], a[212:215]
    ds_read_b64_tr_b16 a[108:109], v17 offset:33800
    ds_read_b64_tr_b16 a[110:111], v17 offset:35864
    v_mfma_f32_16x16x32_bf16 a[208:211], a[116:119], v[200:203], a[208:211]
    v_accvgpr_read_b32 v45, a189
    v_accvgpr_read_b32 v46, a190
    v_mfma_f32_16x16x32_bf16 a[204:207], a[116:119], v[196:199], a[204:207]
    v_accvgpr_read_b32 v47, a191
    s_waitcnt lgkmcnt(8)
    v_mfma_f32_16x16x32_bf16 a[216:219], a[120:123], v[196:199], a[216:219]
    ds_read_b64_tr_b16 a[112:113], v14 offset:37920
    ds_read_b64_tr_b16 a[114:115], v14 offset:39984
    v_mfma_f32_16x16x32_bf16 a[220:223], a[120:123], v[200:203], a[220:223]
    buffer_load_dwordx4 v11, s[16:19], s30 offen offset:2064 nt lds
    v_mfma_f32_16x16x32_bf16 a[224:227], a[120:123], v[204:207], a[224:227]
    v_mul_f32 v40, v30, v40
    v_mul_f32 v41, v30, v41
    v_mfma_f32_16x16x32_bf16 a[236:239], a[124:127], v[204:207], a[236:239]
    ds_read_b64_tr_b16 a[116:117], v14 offset:37928
    ds_read_b64_tr_b16 a[118:119], v14 offset:39992
    v_mfma_f32_16x16x32_bf16 a[232:235], a[124:127], v[200:203], a[232:235]
    v_mul_f32 v42, v30, v42
    v_mul_f32 v43, v30, v43
    v_mfma_f32_16x16x32_bf16 a[228:231], a[124:127], v[196:199], a[228:231]
    v_mul_f32 v44, v30, v44
    s_waitcnt lgkmcnt(8)
    v_mfma_f32_16x16x32_bf16 a[192:195], a[96:99], v[208:211], a[192:195]
    ds_read_b64_tr_b16 a[120:121], v17 offset:37920
    ds_read_b64_tr_b16 a[122:123], v17 offset:39984
    v_mfma_f32_16x16x32_bf16 a[196:199], a[96:99], v[212:215], a[196:199]
    buffer_load_dwordx4 v12, s[16:19], s30 offen offset:3096 nt lds
    v_mfma_f32_16x16x32_bf16 a[200:203], a[96:99], v[216:219], a[200:203]
    v_mul_f32 v45, v30, v45
    v_mul_f32 v46, v30, v46
    v_mfma_f32_16x16x32_bf16 a[212:215], a[100:103], v[216:219], a[212:215]
    ds_read_b64_tr_b16 a[124:125], v17 offset:37928
    ds_read_b64_tr_b16 a[126:127], v17 offset:39992
    v_mfma_f32_16x16x32_bf16 a[208:211], a[100:103], v[212:215], a[208:211]
    v_mul_f32 v47, v30, v47
    v_cvt_pk_bf16_f32 v52, v40, v41
    v_mfma_f32_16x16x32_bf16 a[204:207], a[100:103], v[208:211], a[204:207]
    v_cvt_pk_bf16_f32 v53, v42, v43
    s_waitcnt lgkmcnt(8)
    v_mfma_f32_16x16x32_bf16 a[216:219], a[104:107], v[208:211], a[216:219]
    ds_read_b64_tr_b16 a[96:97], v14 offset:42048
    ds_read_b64_tr_b16 a[98:99], v14 offset:44112
    v_mfma_f32_16x16x32_bf16 a[220:223], a[104:107], v[212:215], a[220:223]
    v_cvt_pk_bf16_f32 v54, v44, v45
    v_cvt_pk_bf16_f32 v55, v46, v47
    v_mfma_f32_16x16x32_bf16 a[224:227], a[104:107], v[216:219], a[224:227]
    v_accvgpr_write_b32 a164, v52
    v_accvgpr_write_b32 a165, v53
    v_mfma_f32_16x16x32_bf16 a[236:239], a[108:111], v[216:219], a[236:239]
    ds_read_b64_tr_b16 a[100:101], v14 offset:42056
    ds_read_b64_tr_b16 a[102:103], v14 offset:44120
    v_mfma_f32_16x16x32_bf16 a[232:235], a[108:111], v[212:215], a[232:235]
    v_accvgpr_write_b32 a166, v54
    v_accvgpr_write_b32 a167, v55
    v_mfma_f32_16x16x32_bf16 a[228:231], a[108:111], v[208:211], a[228:231]
    s_waitcnt lgkmcnt(8)
    v_mfma_f32_16x16x32_bf16 a[192:195], a[112:115], v[220:223], a[192:195]
    ds_read_b64_tr_b16 a[104:105], v17 offset:42048
    ds_read_b64_tr_b16 a[106:107], v17 offset:44112
    v_mfma_f32_16x16x32_bf16 a[196:199], a[112:115], v[224:227], a[196:199]
    v_mfma_f32_16x16x32_bf16 a[200:203], a[112:115], v[228:231], a[200:203]
    v_mfma_f32_16x16x32_bf16 a[212:215], a[116:119], v[228:231], a[212:215]
    ds_read_b64_tr_b16 a[108:109], v17 offset:42056
    ds_read_b64_tr_b16 a[110:111], v17 offset:44120
    v_mfma_f32_16x16x32_bf16 a[208:211], a[116:119], v[224:227], a[208:211]
    v_mfma_f32_16x16x32_bf16 a[204:207], a[116:119], v[220:223], a[204:207]
    s_waitcnt lgkmcnt(8)
    v_mfma_f32_16x16x32_bf16 a[216:219], a[120:123], v[220:223], a[216:219]
    ds_read_b64_tr_b16 a[112:113], v14 offset:46176
    ds_read_b64_tr_b16 a[114:115], v14 offset:48240
    v_mfma_f32_16x16x32_bf16 a[220:223], a[120:123], v[224:227], a[220:223]
    v_mfma_f32_16x16x32_bf16 a[224:227], a[120:123], v[228:231], a[224:227]
    v_mfma_f32_16x16x32_bf16 a[236:239], a[124:127], v[228:231], a[236:239]
    ds_read_b64_tr_b16 a[116:117], v14 offset:46184
    ds_read_b64_tr_b16 a[118:119], v14 offset:48248
    v_mfma_f32_16x16x32_bf16 a[232:235], a[124:127], v[224:227], a[232:235]
    v_mfma_f32_16x16x32_bf16 a[228:231], a[124:127], v[220:223], a[228:231]
    s_waitcnt lgkmcnt(8)
    v_mfma_f32_16x16x32_bf16 a[192:195], a[96:99], v[232:235], a[192:195]
    ds_read_b64_tr_b16 a[120:121], v17 offset:46176
    ds_read_b64_tr_b16 a[122:123], v17 offset:48240
    v_mfma_f32_16x16x32_bf16 a[196:199], a[96:99], v[236:239], a[196:199]
    v_mfma_f32_16x16x32_bf16 a[200:203], a[96:99], v[240:243], a[200:203]
    v_mfma_f32_16x16x32_bf16 a[212:215], a[100:103], v[240:243], a[212:215]
    ds_read_b64_tr_b16 a[124:125], v17 offset:46184
    ds_read_b64_tr_b16 a[126:127], v17 offset:48248
    v_mfma_f32_16x16x32_bf16 a[208:211], a[100:103], v[236:239], a[208:211]
    s_waitcnt vmcnt(16)
    s_barrier
    v_mfma_f32_16x16x32_bf16 a[204:207], a[100:103], v[232:235], a[204:207]
    s_add_u32 m0, s29, 50688
    s_waitcnt lgkmcnt(8)
    v_mfma_f32_16x16x32_bf16 a[216:219], a[104:107], v[232:235], a[216:219]
    ds_read_b64_tr_b16 a[96:97], v15 offset:0
    ds_read_b64_tr_b16 a[98:99], v15 offset:2064
    v_mfma_f32_16x16x32_bf16 a[220:223], a[104:107], v[236:239], a[220:223]
    s_mov_b32 s30, 131456
    v_mfma_f32_16x16x32_bf16 a[224:227], a[104:107], v[240:243], a[224:227]
    buffer_load_dwordx4 v9, s[16:19], s30 offen offset:0 nt lds
    v_mfma_f32_16x16x32_bf16 a[236:239], a[108:111], v[240:243], a[236:239]
    ds_read_b64_tr_b16 a[100:101], v15 offset:8
    ds_read_b64_tr_b16 a[102:103], v15 offset:2072
    v_mfma_f32_16x16x32_bf16 a[232:235], a[108:111], v[236:239], a[232:235]
    v_mfma_f32_16x16x32_bf16 a[228:231], a[108:111], v[232:235], a[228:231]
    s_waitcnt lgkmcnt(8)
    v_mfma_f32_16x16x32_bf16 a[192:195], a[112:115], v[244:247], a[192:195]
    ds_read_b64_tr_b16 a[104:105], v18 offset:0
    ds_read_b64_tr_b16 a[106:107], v18 offset:2064
    v_mfma_f32_16x16x32_bf16 a[196:199], a[112:115], v[248:251], a[196:199]
    buffer_load_dwordx4 v10, s[16:19], s30 offen offset:1032 nt lds
    v_mfma_f32_16x16x32_bf16 a[200:203], a[112:115], v[252:255], a[200:203]
    v_mfma_f32_16x16x32_bf16 a[212:215], a[116:119], v[252:255], a[212:215]
    ds_read_b64_tr_b16 a[108:109], v18 offset:8
    ds_read_b64_tr_b16 a[110:111], v18 offset:2072
    v_mfma_f32_16x16x32_bf16 a[208:211], a[116:119], v[248:251], a[208:211]
    v_mfma_f32_16x16x32_bf16 a[204:207], a[116:119], v[244:247], a[204:207]
    s_waitcnt lgkmcnt(8)
    v_mfma_f32_16x16x32_bf16 a[216:219], a[120:123], v[244:247], a[216:219]
    ds_read_b64_tr_b16 a[112:113], v15 offset:4128
    ds_read_b64_tr_b16 a[114:115], v15 offset:6192
    v_mfma_f32_16x16x32_bf16 a[220:223], a[120:123], v[248:251], a[220:223]
    buffer_load_dwordx4 v11, s[16:19], s30 offen offset:2064 nt lds
    v_mfma_f32_16x16x32_bf16 a[224:227], a[120:123], v[252:255], a[224:227]
    v_mfma_f32_16x16x32_bf16 a[236:239], a[124:127], v[252:255], a[236:239]
    ds_read_b64_tr_b16 a[116:117], v15 offset:4136
    ds_read_b64_tr_b16 a[118:119], v15 offset:6200
    v_mfma_f32_16x16x32_bf16 a[232:235], a[124:127], v[248:251], a[232:235]
    v_mfma_f32_16x16x32_bf16 a[228:231], a[124:127], v[244:247], a[228:231]
    s_waitcnt lgkmcnt(8)
    v_mfma_f32_16x16x32_bf16 a[0:3], a[96:99], v[64:67], 0
    ds_read_b64_tr_b16 a[120:121], v18 offset:4128
    ds_read_b64_tr_b16 a[122:123], v18 offset:6192
    v_mfma_f32_16x16x32_bf16 a[4:7], a[96:99], v[68:71], 0
    buffer_load_dwordx4 v12, s[16:19], s30 offen offset:3096 nt lds
    v_mfma_f32_16x16x32_bf16 a[8:11], a[96:99], v[72:75], 0
    v_mfma_f32_16x16x32_bf16 a[20:23], a[100:103], v[72:75], 0
    ds_read_b64_tr_b16 a[124:125], v18 offset:4136
    ds_read_b64_tr_b16 a[126:127], v18 offset:6200
    v_mfma_f32_16x16x32_bf16 a[16:19], a[100:103], v[68:71], 0
    v_accvgpr_read_b32 v40, a192
    v_accvgpr_read_b32 v41, a193
    v_mfma_f32_16x16x32_bf16 a[12:15], a[100:103], v[64:67], 0
    v_accvgpr_read_b32 v42, a194
    s_waitcnt lgkmcnt(8)
    v_mfma_f32_16x16x32_bf16 a[24:27], a[104:107], v[64:67], 0
    ds_read_b64_tr_b16 a[96:97], v15 offset:8256
    ds_read_b64_tr_b16 a[98:99], v15 offset:10320
    v_mfma_f32_16x16x32_bf16 a[28:31], a[104:107], v[68:71], 0
    v_accvgpr_read_b32 v43, a195
    v_accvgpr_read_b32 v44, a204
    v_mfma_f32_16x16x32_bf16 a[32:35], a[104:107], v[72:75], 0
    v_accvgpr_read_b32 v45, a205
    v_accvgpr_read_b32 v46, a206
    v_mfma_f32_16x16x32_bf16 a[44:47], a[108:111], v[72:75], 0
    ds_read_b64_tr_b16 a[100:101], v15 offset:8264
    ds_read_b64_tr_b16 a[102:103], v15 offset:10328
    v_mfma_f32_16x16x32_bf16 a[40:43], a[108:111], v[68:71], 0
    v_accvgpr_read_b32 v47, a207
    v_mul_f32 v40, v28, v40
    v_mfma_f32_16x16x32_bf16 a[36:39], a[108:111], v[64:67], 0
    v_mul_f32 v41, v28, v41
    s_waitcnt lgkmcnt(8)
    v_mfma_f32_16x16x32_bf16 a[0:3], a[112:115], v[76:79], a[0:3]
    ds_read_b64_tr_b16 a[104:105], v18 offset:8256
    ds_read_b64_tr_b16 a[106:107], v18 offset:10320
    v_mfma_f32_16x16x32_bf16 a[4:7], a[112:115], v[80:83], a[4:7]
    v_mul_f32 v42, v28, v42
    v_mul_f32 v43, v28, v43
    v_mfma_f32_16x16x32_bf16 a[8:11], a[112:115], v[84:87], a[8:11]
    v_mul_f32 v44, v28, v44
    v_mul_f32 v45, v28, v45
    v_mfma_f32_16x16x32_bf16 a[20:23], a[116:119], v[84:87], a[20:23]
    ds_read_b64_tr_b16 a[108:109], v18 offset:8264
    ds_read_b64_tr_b16 a[110:111], v18 offset:10328
    v_mfma_f32_16x16x32_bf16 a[16:19], a[116:119], v[80:83], a[16:19]
    v_mul_f32 v46, v28, v46
    v_mul_f32 v47, v28, v47
    v_mfma_f32_16x16x32_bf16 a[12:15], a[116:119], v[76:79], a[12:15]
    v_cvt_pk_bf16_f32 v48, v40, v41
    s_waitcnt lgkmcnt(8)
    v_mfma_f32_16x16x32_bf16 a[24:27], a[120:123], v[76:79], a[24:27]
    ds_read_b64_tr_b16 a[112:113], v15 offset:12384
    ds_read_b64_tr_b16 a[114:115], v15 offset:14448
    v_mfma_f32_16x16x32_bf16 a[28:31], a[120:123], v[80:83], a[28:31]
    v_cvt_pk_bf16_f32 v49, v42, v43
    v_cvt_pk_bf16_f32 v50, v44, v45
    v_mfma_f32_16x16x32_bf16 a[32:35], a[120:123], v[84:87], a[32:35]
    v_cvt_pk_bf16_f32 v51, v46, v47
    v_accvgpr_write_b32 a192, v48
    v_mfma_f32_16x16x32_bf16 a[44:47], a[124:127], v[84:87], a[44:47]
    ds_read_b64_tr_b16 a[116:117], v15 offset:12392
    ds_read_b64_tr_b16 a[118:119], v15 offset:14456
    v_mfma_f32_16x16x32_bf16 a[40:43], a[124:127], v[80:83], a[40:43]
    v_accvgpr_write_b32 a193, v49
    v_accvgpr_write_b32 a194, v50
    v_mfma_f32_16x16x32_bf16 a[36:39], a[124:127], v[76:79], a[36:39]
    v_accvgpr_write_b32 a195, v51
    s_waitcnt lgkmcnt(8)
    v_mfma_f32_16x16x32_bf16 a[0:3], a[96:99], v[88:91], a[0:3]
    ds_read_b64_tr_b16 a[120:121], v18 offset:12384
    ds_read_b64_tr_b16 a[122:123], v18 offset:14448
    v_mfma_f32_16x16x32_bf16 a[4:7], a[96:99], v[92:95], a[4:7]
    v_accvgpr_read_b32 v40, a216
    v_accvgpr_read_b32 v41, a217
    v_mfma_f32_16x16x32_bf16 a[8:11], a[96:99], v[96:99], a[8:11]
    v_accvgpr_read_b32 v42, a218
    v_accvgpr_read_b32 v43, a219
    v_mfma_f32_16x16x32_bf16 a[20:23], a[100:103], v[96:99], a[20:23]
    ds_read_b64_tr_b16 a[124:125], v18 offset:12392
    ds_read_b64_tr_b16 a[126:127], v18 offset:14456
    v_mfma_f32_16x16x32_bf16 a[16:19], a[100:103], v[92:95], a[16:19]
    v_accvgpr_read_b32 v44, a228
    v_accvgpr_read_b32 v45, a229
    v_mfma_f32_16x16x32_bf16 a[12:15], a[100:103], v[88:91], a[12:15]
    s_add_u32 m0, s29, 67584
    s_waitcnt lgkmcnt(8)
    v_mfma_f32_16x16x32_bf16 a[24:27], a[104:107], v[88:91], a[24:27]
    ds_read_b64_tr_b16 a[96:97], v15 offset:16896
    ds_read_b64_tr_b16 a[98:99], v15 offset:18960
    v_mfma_f32_16x16x32_bf16 a[28:31], a[104:107], v[92:95], a[28:31]
    s_mov_b32 s30, 196992
    v_accvgpr_read_b32 v46, a230
    v_mfma_f32_16x16x32_bf16 a[32:35], a[104:107], v[96:99], a[32:35]
    buffer_load_dwordx4 v9, s[16:19], s30 offen offset:0 nt lds
    v_mfma_f32_16x16x32_bf16 a[44:47], a[108:111], v[96:99], a[44:47]
    ds_read_b64_tr_b16 a[100:101], v15 offset:16904
    ds_read_b64_tr_b16 a[102:103], v15 offset:18968
    v_mfma_f32_16x16x32_bf16 a[40:43], a[108:111], v[92:95], a[40:43]
    v_accvgpr_read_b32 v47, a231
    v_mul_f32 v40, v28, v40
    v_mfma_f32_16x16x32_bf16 a[36:39], a[108:111], v[88:91], a[36:39]
    v_mul_f32 v41, v28, v41
    s_waitcnt lgkmcnt(8)
    v_mfma_f32_16x16x32_bf16 a[0:3], a[112:115], v[100:103], a[0:3]
    ds_read_b64_tr_b16 a[104:105], v18 offset:16896
    ds_read_b64_tr_b16 a[106:107], v18 offset:18960
    v_mfma_f32_16x16x32_bf16 a[4:7], a[112:115], v[104:107], a[4:7]
    buffer_load_dwordx4 v10, s[16:19], s30 offen offset:1032 nt lds
    v_mfma_f32_16x16x32_bf16 a[8:11], a[112:115], v[108:111], a[8:11]
    v_mul_f32 v42, v28, v42
    v_mul_f32 v43, v28, v43
    v_mfma_f32_16x16x32_bf16 a[20:23], a[116:119], v[108:111], a[20:23]
    ds_read_b64_tr_b16 a[108:109], v18 offset:16904
    ds_read_b64_tr_b16 a[110:111], v18 offset:18968
    v_mfma_f32_16x16x32_bf16 a[16:19], a[116:119], v[104:107], a[16:19]
    v_mul_f32 v44, v28, v44
    v_mul_f32 v45, v28, v45
    v_mfma_f32_16x16x32_bf16 a[12:15], a[116:119], v[100:103], a[12:15]
    v_mul_f32 v46, v28, v46
    s_waitcnt lgkmcnt(8)
    v_mfma_f32_16x16x32_bf16 a[24:27], a[120:123], v[100:103], a[24:27]
    ds_read_b64_tr_b16 a[112:113], v15 offset:21024
    ds_read_b64_tr_b16 a[114:115], v15 offset:23088
    v_mfma_f32_16x16x32_bf16 a[28:31], a[120:123], v[104:107], a[28:31]
    buffer_load_dwordx4 v11, s[16:19], s30 offen offset:2064 nt lds
    v_mfma_f32_16x16x32_bf16 a[32:35], a[120:123], v[108:111], a[32:35]
    v_mul_f32 v47, v28, v47
    v_cvt_pk_bf16_f32 v52, v40, v41
    v_mfma_f32_16x16x32_bf16 a[44:47], a[124:127], v[108:111], a[44:47]
    ds_read_b64_tr_b16 a[116:117], v15 offset:21032
    ds_read_b64_tr_b16 a[118:119], v15 offset:23096
    v_mfma_f32_16x16x32_bf16 a[40:43], a[124:127], v[104:107], a[40:43]
    v_cvt_pk_bf16_f32 v53, v42, v43
    v_cvt_pk_bf16_f32 v54, v44, v45
    v_mfma_f32_16x16x32_bf16 a[36:39], a[124:127], v[100:103], a[36:39]
    v_cvt_pk_bf16_f32 v55, v46, v47
    s_waitcnt lgkmcnt(8)
    v_mfma_f32_16x16x32_bf16 a[0:3], a[96:99], v[112:115], a[0:3]
    ds_read_b64_tr_b16 a[120:121], v18 offset:21024
    ds_read_b64_tr_b16 a[122:123], v18 offset:23088
    v_mfma_f32_16x16x32_bf16 a[4:7], a[96:99], v[116:119], a[4:7]
    buffer_load_dwordx4 v12, s[16:19], s30 offen offset:3096 nt lds
    v_mfma_f32_16x16x32_bf16 a[8:11], a[96:99], v[120:123], a[8:11]
    v_accvgpr_write_b32 a204, v52
    v_accvgpr_write_b32 a205, v53
    v_mfma_f32_16x16x32_bf16 a[20:23], a[100:103], v[120:123], a[20:23]
    ds_read_b64_tr_b16 a[124:125], v18 offset:21032
    ds_read_b64_tr_b16 a[126:127], v18 offset:23096
    v_mfma_f32_16x16x32_bf16 a[16:19], a[100:103], v[116:119], a[16:19]
    v_accvgpr_write_b32 a206, v54
    v_accvgpr_write_b32 a207, v55
    v_mfma_f32_16x16x32_bf16 a[12:15], a[100:103], v[112:115], a[12:15]
    v_accvgpr_read_b32 v40, a196
    s_waitcnt lgkmcnt(8)
    v_mfma_f32_16x16x32_bf16 a[24:27], a[104:107], v[112:115], a[24:27]
    ds_read_b64_tr_b16 a[96:97], v15 offset:25152
    ds_read_b64_tr_b16 a[98:99], v15 offset:27216
    v_mfma_f32_16x16x32_bf16 a[28:31], a[104:107], v[116:119], a[28:31]
    v_accvgpr_read_b32 v41, a197
    v_accvgpr_read_b32 v42, a198
    v_mfma_f32_16x16x32_bf16 a[32:35], a[104:107], v[120:123], a[32:35]
    v_accvgpr_read_b32 v43, a199
    v_accvgpr_read_b32 v44, a208
    v_mfma_f32_16x16x32_bf16 a[44:47], a[108:111], v[120:123], a[44:47]
    ds_read_b64_tr_b16 a[100:101], v15 offset:25160
    ds_read_b64_tr_b16 a[102:103], v15 offset:27224
    v_mfma_f32_16x16x32_bf16 a[40:43], a[108:111], v[116:119], a[40:43]
    v_accvgpr_read_b32 v45, a209
    v_accvgpr_read_b32 v46, a210
    v_mfma_f32_16x16x32_bf16 a[36:39], a[108:111], v[112:115], a[36:39]
    v_accvgpr_read_b32 v47, a211
    s_waitcnt lgkmcnt(8)
    v_mfma_f32_16x16x32_bf16 a[0:3], a[112:115], v[124:127], a[0:3]
    ds_read_b64_tr_b16 a[104:105], v18 offset:25152
    ds_read_b64_tr_b16 a[106:107], v18 offset:27216
    v_mfma_f32_16x16x32_bf16 a[4:7], a[112:115], v[128:131], a[4:7]
    v_mul_f32 v40, v29, v40
    v_mul_f32 v41, v29, v41
    v_mfma_f32_16x16x32_bf16 a[8:11], a[112:115], v[132:135], a[8:11]
    v_mul_f32 v42, v29, v42
    v_mul_f32 v43, v29, v43
    v_mfma_f32_16x16x32_bf16 a[20:23], a[116:119], v[132:135], a[20:23]
    ds_read_b64_tr_b16 a[108:109], v18 offset:25160
    ds_read_b64_tr_b16 a[110:111], v18 offset:27224
    v_mfma_f32_16x16x32_bf16 a[16:19], a[116:119], v[128:131], a[16:19]
    v_mul_f32 v44, v29, v44
    v_mul_f32 v45, v29, v45
    v_mfma_f32_16x16x32_bf16 a[12:15], a[116:119], v[124:127], a[12:15]
    v_mul_f32 v46, v29, v46
    s_waitcnt lgkmcnt(8)
    v_mfma_f32_16x16x32_bf16 a[24:27], a[120:123], v[124:127], a[24:27]
    ds_read_b64_tr_b16 a[112:113], v15 offset:29280
    ds_read_b64_tr_b16 a[114:115], v15 offset:31344
    v_mfma_f32_16x16x32_bf16 a[28:31], a[120:123], v[128:131], a[28:31]
    v_mul_f32 v47, v29, v47
    v_cvt_pk_bf16_f32 v48, v40, v41
    v_mfma_f32_16x16x32_bf16 a[32:35], a[120:123], v[132:135], a[32:35]
    v_cvt_pk_bf16_f32 v49, v42, v43
    v_cvt_pk_bf16_f32 v50, v44, v45
    v_mfma_f32_16x16x32_bf16 a[44:47], a[124:127], v[132:135], a[44:47]
    ds_read_b64_tr_b16 a[116:117], v15 offset:29288
    ds_read_b64_tr_b16 a[118:119], v15 offset:31352
    v_mfma_f32_16x16x32_bf16 a[40:43], a[124:127], v[128:131], a[40:43]
    v_cvt_pk_bf16_f32 v51, v46, v47
    v_accvgpr_write_b32 a196, v48
    v_mfma_f32_16x16x32_bf16 a[36:39], a[124:127], v[124:127], a[36:39]
    v_accvgpr_write_b32 a197, v49
    s_waitcnt lgkmcnt(8)
    v_mfma_f32_16x16x32_bf16 a[0:3], a[96:99], v[136:139], a[0:3]
    ds_read_b64_tr_b16 a[120:121], v18 offset:29280
    ds_read_b64_tr_b16 a[122:123], v18 offset:31344
    v_mfma_f32_16x16x32_bf16 a[4:7], a[96:99], v[140:143], a[4:7]
    v_accvgpr_write_b32 a198, v50
    v_accvgpr_write_b32 a199, v51
    v_mfma_f32_16x16x32_bf16 a[8:11], a[96:99], v[144:147], a[8:11]
    v_accvgpr_read_b32 v40, a220
    v_accvgpr_read_b32 v41, a221
    v_mfma_f32_16x16x32_bf16 a[20:23], a[100:103], v[144:147], a[20:23]
    ds_read_b64_tr_b16 a[124:125], v18 offset:29288
    ds_read_b64_tr_b16 a[126:127], v18 offset:31352
    v_mfma_f32_16x16x32_bf16 a[16:19], a[100:103], v[140:143], a[16:19]
    s_waitcnt vmcnt(16)
    s_barrier
    v_mfma_f32_16x16x32_bf16 a[12:15], a[100:103], v[136:139], a[12:15]
    v_accvgpr_read_b32 v42, a222
    s_waitcnt lgkmcnt(8)
    v_mfma_f32_16x16x32_bf16 a[24:27], a[104:107], v[136:139], a[24:27]
    ds_read_b64_tr_b16 a[96:97], v15 offset:33792
    ds_read_b64_tr_b16 a[98:99], v15 offset:35856
    v_mfma_f32_16x16x32_bf16 a[28:31], a[104:107], v[140:143], a[28:31]
    v_accvgpr_read_b32 v43, a223
    v_accvgpr_read_b32 v44, a232
    v_mfma_f32_16x16x32_bf16 a[32:35], a[104:107], v[144:147], a[32:35]
    v_accvgpr_read_b32 v45, a233
    v_accvgpr_read_b32 v46, a234
    v_mfma_f32_16x16x32_bf16 a[44:47], a[108:111], v[144:147], a[44:47]
    ds_read_b64_tr_b16 a[100:101], v15 offset:33800
    ds_read_b64_tr_b16 a[102:103], v15 offset:35864
    v_mfma_f32_16x16x32_bf16 a[40:43], a[108:111], v[140:143], a[40:43]
    v_accvgpr_read_b32 v47, a235
    v_mul_f32 v40, v29, v40
    v_mfma_f32_16x16x32_bf16 a[36:39], a[108:111], v[136:139], a[36:39]
    v_mul_f32 v41, v29, v41
    s_waitcnt lgkmcnt(8)
    v_mfma_f32_16x16x32_bf16 a[0:3], a[112:115], v[148:151], a[0:3]
    ds_read_b64_tr_b16 a[104:105], v18 offset:33792
    ds_read_b64_tr_b16 a[106:107], v18 offset:35856
    v_mfma_f32_16x16x32_bf16 a[4:7], a[112:115], v[152:155], a[4:7]
    v_mul_f32 v42, v29, v42
    v_mul_f32 v43, v29, v43
    v_mfma_f32_16x16x32_bf16 a[8:11], a[112:115], v[156:159], a[8:11]
    v_mul_f32 v44, v29, v44
    v_mul_f32 v45, v29, v45
    v_mfma_f32_16x16x32_bf16 a[20:23], a[116:119], v[156:159], a[20:23]
    ds_read_b64_tr_b16 a[108:109], v18 offset:33800
    ds_read_b64_tr_b16 a[110:111], v18 offset:35864
    v_mfma_f32_16x16x32_bf16 a[16:19], a[116:119], v[152:155], a[16:19]
    v_mul_f32 v46, v29, v46
    v_mul_f32 v47, v29, v47
    v_mfma_f32_16x16x32_bf16 a[12:15], a[116:119], v[148:151], a[12:15]
    v_cvt_pk_bf16_f32 v52, v40, v41
    s_waitcnt lgkmcnt(8)
    v_mfma_f32_16x16x32_bf16 a[24:27], a[120:123], v[148:151], a[24:27]
    ds_read_b64_tr_b16 a[112:113], v15 offset:37920
    ds_read_b64_tr_b16 a[114:115], v15 offset:39984
    v_mfma_f32_16x16x32_bf16 a[28:31], a[120:123], v[152:155], a[28:31]
    v_cvt_pk_bf16_f32 v53, v42, v43
    v_cvt_pk_bf16_f32 v54, v44, v45
    v_mfma_f32_16x16x32_bf16 a[32:35], a[120:123], v[156:159], a[32:35]
    v_cvt_pk_bf16_f32 v55, v46, v47
    v_accvgpr_write_b32 a208, v52
    v_mfma_f32_16x16x32_bf16 a[44:47], a[124:127], v[156:159], a[44:47]
    ds_read_b64_tr_b16 a[116:117], v15 offset:37928
    ds_read_b64_tr_b16 a[118:119], v15 offset:39992
    v_mfma_f32_16x16x32_bf16 a[40:43], a[124:127], v[152:155], a[40:43]
    v_accvgpr_write_b32 a209, v53
    v_accvgpr_write_b32 a210, v54
    v_mfma_f32_16x16x32_bf16 a[36:39], a[124:127], v[148:151], a[36:39]
    v_accvgpr_write_b32 a211, v55
    s_waitcnt lgkmcnt(8)
    v_mfma_f32_16x16x32_bf16 a[0:3], a[96:99], v[160:163], a[0:3]
    ds_read_b64_tr_b16 a[120:121], v18 offset:37920
    ds_read_b64_tr_b16 a[122:123], v18 offset:39984
    v_mfma_f32_16x16x32_bf16 a[4:7], a[96:99], v[164:167], a[4:7]
    v_accvgpr_read_b32 v40, a200
    v_accvgpr_read_b32 v41, a201
    v_mfma_f32_16x16x32_bf16 a[8:11], a[96:99], v[168:171], a[8:11]
    v_accvgpr_read_b32 v42, a202
    v_accvgpr_read_b32 v43, a203
    v_mfma_f32_16x16x32_bf16 a[20:23], a[100:103], v[168:171], a[20:23]
    ds_read_b64_tr_b16 a[124:125], v18 offset:37928
    ds_read_b64_tr_b16 a[126:127], v18 offset:39992
    v_mfma_f32_16x16x32_bf16 a[16:19], a[100:103], v[164:167], a[16:19]
    v_accvgpr_read_b32 v44, a212
    v_accvgpr_read_b32 v45, a213
    v_mfma_f32_16x16x32_bf16 a[12:15], a[100:103], v[160:163], a[12:15]
    v_accvgpr_read_b32 v46, a214
    s_waitcnt lgkmcnt(8)
    v_mfma_f32_16x16x32_bf16 a[24:27], a[104:107], v[160:163], a[24:27]
    ds_read_b64_tr_b16 a[96:97], v15 offset:42048
    ds_read_b64_tr_b16 a[98:99], v15 offset:44112
    v_mfma_f32_16x16x32_bf16 a[28:31], a[104:107], v[164:167], a[28:31]
    v_accvgpr_read_b32 v47, a215
    v_mul_f32 v40, v30, v40
    v_mfma_f32_16x16x32_bf16 a[32:35], a[104:107], v[168:171], a[32:35]
    v_mul_f32 v41, v30, v41
    v_mul_f32 v42, v30, v42
    v_mfma_f32_16x16x32_bf16 a[44:47], a[108:111], v[168:171], a[44:47]
    ds_read_b64_tr_b16 a[100:101], v15 offset:42056
    ds_read_b64_tr_b16 a[102:103], v15 offset:44120
    v_mfma_f32_16x16x32_bf16 a[40:43], a[108:111], v[164:167], a[40:43]
    v_mul_f32 v43, v30, v43
    v_mul_f32 v44, v30, v44
    v_mfma_f32_16x16x32_bf16 a[36:39], a[108:111], v[160:163], a[36:39]
    v_mul_f32 v45, v30, v45
    s_waitcnt lgkmcnt(8)
    v_mfma_f32_16x16x32_bf16 a[0:3], a[112:115], v[172:175], a[0:3]
    ds_read_b64_tr_b16 a[104:105], v18 offset:42048
    ds_read_b64_tr_b16 a[106:107], v18 offset:44112
    v_mfma_f32_16x16x32_bf16 a[4:7], a[112:115], v[176:179], a[4:7]
    v_mul_f32 v46, v30, v46
    v_mul_f32 v47, v30, v47
    v_mfma_f32_16x16x32_bf16 a[8:11], a[112:115], v[180:183], a[8:11]
    v_cvt_pk_bf16_f32 v48, v40, v41
    v_cvt_pk_bf16_f32 v49, v42, v43
    v_mfma_f32_16x16x32_bf16 a[20:23], a[116:119], v[180:183], a[20:23]
    ds_read_b64_tr_b16 a[108:109], v18 offset:42056
    ds_read_b64_tr_b16 a[110:111], v18 offset:44120
    v_mfma_f32_16x16x32_bf16 a[16:19], a[116:119], v[176:179], a[16:19]
    v_cvt_pk_bf16_f32 v50, v44, v45
    v_cvt_pk_bf16_f32 v51, v46, v47
    v_mfma_f32_16x16x32_bf16 a[12:15], a[116:119], v[172:175], a[12:15]
    v_accvgpr_write_b32 a200, v48
    s_waitcnt lgkmcnt(8)
    v_mfma_f32_16x16x32_bf16 a[24:27], a[120:123], v[172:175], a[24:27]
    ds_read_b64_tr_b16 a[112:113], v15 offset:46176
    ds_read_b64_tr_b16 a[114:115], v15 offset:48240
    v_mfma_f32_16x16x32_bf16 a[28:31], a[120:123], v[176:179], a[28:31]
    v_accvgpr_write_b32 a201, v49
    v_accvgpr_write_b32 a202, v50
    v_mfma_f32_16x16x32_bf16 a[32:35], a[120:123], v[180:183], a[32:35]
    v_accvgpr_write_b32 a203, v51
    v_accvgpr_read_b32 v40, a224
    v_mfma_f32_16x16x32_bf16 a[44:47], a[124:127], v[180:183], a[44:47]
    ds_read_b64_tr_b16 a[116:117], v15 offset:46184
    ds_read_b64_tr_b16 a[118:119], v15 offset:48248
    v_mfma_f32_16x16x32_bf16 a[40:43], a[124:127], v[176:179], a[40:43]
    v_accvgpr_read_b32 v41, a225
    v_accvgpr_read_b32 v42, a226
    v_mfma_f32_16x16x32_bf16 a[36:39], a[124:127], v[172:175], a[36:39]
    v_accvgpr_read_b32 v43, a227
    s_waitcnt lgkmcnt(8)
    v_mfma_f32_16x16x32_bf16 a[0:3], a[96:99], v[184:187], a[0:3]
    ds_read_b64_tr_b16 a[120:121], v18 offset:46176
    ds_read_b64_tr_b16 a[122:123], v18 offset:48240
    v_mfma_f32_16x16x32_bf16 a[4:7], a[96:99], v[188:191], a[4:7]
    v_accvgpr_read_b32 v44, a236
    v_accvgpr_read_b32 v45, a237
    v_mfma_f32_16x16x32_bf16 a[8:11], a[96:99], v[192:195], a[8:11]
    v_accvgpr_read_b32 v46, a238
    v_accvgpr_read_b32 v47, a239
    v_mfma_f32_16x16x32_bf16 a[20:23], a[100:103], v[192:195], a[20:23]
    ds_read_b64_tr_b16 a[124:125], v18 offset:46184
    ds_read_b64_tr_b16 a[126:127], v18 offset:48248
    v_mfma_f32_16x16x32_bf16 a[16:19], a[100:103], v[188:191], a[16:19]
    v_mul_f32 v40, v30, v40
    v_mul_f32 v41, v30, v41
    v_mfma_f32_16x16x32_bf16 a[12:15], a[100:103], v[184:187], a[12:15]
    v_mul_f32 v42, v30, v42
    s_waitcnt lgkmcnt(8)
    v_mfma_f32_16x16x32_bf16 a[24:27], a[104:107], v[184:187], a[24:27]
    ds_read_b64_tr_b16 a[96:97], v13 offset:0
    ds_read_b64_tr_b16 a[98:99], v13 offset:2064
    v_mfma_f32_16x16x32_bf16 a[28:31], a[104:107], v[188:191], a[28:31]
    v_mul_f32 v43, v30, v43
    v_mul_f32 v44, v30, v44
    v_mfma_f32_16x16x32_bf16 a[32:35], a[104:107], v[192:195], a[32:35]
    v_mul_f32 v45, v30, v45
    v_mul_f32 v46, v30, v46
    v_mfma_f32_16x16x32_bf16 a[44:47], a[108:111], v[192:195], a[44:47]
    ds_read_b64_tr_b16 a[100:101], v13 offset:8
    ds_read_b64_tr_b16 a[102:103], v13 offset:2072
    v_mfma_f32_16x16x32_bf16 a[40:43], a[108:111], v[188:191], a[40:43]
    v_mul_f32 v47, v30, v47
    v_cvt_pk_bf16_f32 v52, v40, v41
    v_mfma_f32_16x16x32_bf16 a[36:39], a[108:111], v[184:187], a[36:39]
    v_cvt_pk_bf16_f32 v53, v42, v43
    s_waitcnt lgkmcnt(8)
    v_mfma_f32_16x16x32_bf16 a[0:3], a[112:115], v[196:199], a[0:3]
    ds_read_b64_tr_b16 a[104:105], v16 offset:0
    ds_read_b64_tr_b16 a[106:107], v16 offset:2064
    v_mfma_f32_16x16x32_bf16 a[4:7], a[112:115], v[200:203], a[4:7]
    v_cvt_pk_bf16_f32 v54, v44, v45
    v_cvt_pk_bf16_f32 v55, v46, v47
    v_mfma_f32_16x16x32_bf16 a[8:11], a[112:115], v[204:207], a[8:11]
    v_accvgpr_write_b32 a212, v52
    v_accvgpr_write_b32 a213, v53
    v_mfma_f32_16x16x32_bf16 a[20:23], a[116:119], v[204:207], a[20:23]
    ds_read_b64_tr_b16 a[108:109], v16 offset:8
    ds_read_b64_tr_b16 a[110:111], v16 offset:2072
    v_mfma_f32_16x16x32_bf16 a[16:19], a[116:119], v[200:203], a[16:19]
    v_accvgpr_write_b32 a214, v54
    v_accvgpr_write_b32 a215, v55
    v_mfma_f32_16x16x32_bf16 a[12:15], a[116:119], v[196:199], a[12:15]
    s_waitcnt lgkmcnt(8)
    v_mfma_f32_16x16x32_bf16 a[24:27], a[120:123], v[196:199], a[24:27]
    ds_read_b64_tr_b16 a[112:113], v13 offset:4128
    ds_read_b64_tr_b16 a[114:115], v13 offset:6192
    v_mfma_f32_16x16x32_bf16 a[28:31], a[120:123], v[200:203], a[28:31]
    v_mfma_f32_16x16x32_bf16 a[32:35], a[120:123], v[204:207], a[32:35]
    v_mfma_f32_16x16x32_bf16 a[44:47], a[124:127], v[204:207], a[44:47]
    ds_read_b64_tr_b16 a[116:117], v13 offset:4136
    ds_read_b64_tr_b16 a[118:119], v13 offset:6200
    v_mfma_f32_16x16x32_bf16 a[40:43], a[124:127], v[200:203], a[40:43]
    v_mfma_f32_16x16x32_bf16 a[36:39], a[124:127], v[196:199], a[36:39]
    s_waitcnt lgkmcnt(8)
    v_mfma_f32_16x16x32_bf16 a[0:3], a[96:99], v[208:211], a[0:3]
    ds_read_b64_tr_b16 a[120:121], v16 offset:4128
    ds_read_b64_tr_b16 a[122:123], v16 offset:6192
    v_mfma_f32_16x16x32_bf16 a[4:7], a[96:99], v[212:215], a[4:7]
    v_mfma_f32_16x16x32_bf16 a[8:11], a[96:99], v[216:219], a[8:11]
    v_mfma_f32_16x16x32_bf16 a[20:23], a[100:103], v[216:219], a[20:23]
    ds_read_b64_tr_b16 a[124:125], v16 offset:4136
    ds_read_b64_tr_b16 a[126:127], v16 offset:6200
    v_mfma_f32_16x16x32_bf16 a[16:19], a[100:103], v[212:215], a[16:19]
    v_mfma_f32_16x16x32_bf16 a[12:15], a[100:103], v[208:211], a[12:15]
    s_waitcnt lgkmcnt(8)
    v_mfma_f32_16x16x32_bf16 a[24:27], a[104:107], v[208:211], a[24:27]
    ds_read_b64_tr_b16 a[96:97], v13 offset:8256
    ds_read_b64_tr_b16 a[98:99], v13 offset:10320
    v_mfma_f32_16x16x32_bf16 a[28:31], a[104:107], v[212:215], a[28:31]
    v_mfma_f32_16x16x32_bf16 a[32:35], a[104:107], v[216:219], a[32:35]
    v_mfma_f32_16x16x32_bf16 a[44:47], a[108:111], v[216:219], a[44:47]
    ds_read_b64_tr_b16 a[100:101], v13 offset:8264
    ds_read_b64_tr_b16 a[102:103], v13 offset:10328
    v_mfma_f32_16x16x32_bf16 a[40:43], a[108:111], v[212:215], a[40:43]
    v_mfma_f32_16x16x32_bf16 a[36:39], a[108:111], v[208:211], a[36:39]
    ds_write_b64 v22, a[144:145] offset:0
    s_waitcnt lgkmcnt(9)
    v_mfma_f32_16x16x32_bf16 a[0:3], a[112:115], v[220:223], a[0:3]
    ds_read_b64_tr_b16 a[104:105], v16 offset:8256
    ds_read_b64_tr_b16 a[106:107], v16 offset:10320
    v_mfma_f32_16x16x32_bf16 a[4:7], a[112:115], v[224:227], a[4:7]
    ds_write_b64 v22, a[146:147] offset:8
    ds_write_b64 v22, a[156:157] offset:64
    v_mfma_f32_16x16x32_bf16 a[8:11], a[112:115], v[228:231], a[8:11]
    ds_write_b64 v22, a[158:159] offset:72
    v_mfma_f32_16x16x32_bf16 a[20:23], a[116:119], v[228:231], a[20:23]
    ds_read_b64_tr_b16 a[108:109], v16 offset:8264
    ds_read_b64_tr_b16 a[110:111], v16 offset:10328
    v_mfma_f32_16x16x32_bf16 a[16:19], a[116:119], v[224:227], a[16:19]
    ds_read_b128 a[168:171], v23
    ds_read_b128 a[180:183], v23 offset:1152
    v_mfma_f32_16x16x32_bf16 a[12:15], a[116:119], v[220:223], a[12:15]
    s_waitcnt lgkmcnt(14)
    v_mfma_f32_16x16x32_bf16 a[24:27], a[120:123], v[220:223], a[24:27]
    ds_read_b64_tr_b16 a[112:113], v13 offset:12384
    ds_read_b64_tr_b16 a[114:115], v13 offset:14448
    v_mfma_f32_16x16x32_bf16 a[28:31], a[120:123], v[224:227], a[28:31]
    v_mfma_f32_16x16x32_bf16 a[32:35], a[120:123], v[228:231], a[32:35]
    v_mfma_f32_16x16x32_bf16 a[44:47], a[124:127], v[228:231], a[44:47]
    ds_read_b64_tr_b16 a[116:117], v13 offset:12392
    ds_read_b64_tr_b16 a[118:119], v13 offset:14456
    v_mfma_f32_16x16x32_bf16 a[40:43], a[124:127], v[224:227], a[40:43]
    v_mfma_f32_16x16x32_bf16 a[36:39], a[124:127], v[220:223], a[36:39]
    s_waitcnt lgkmcnt(14)
    v_mfma_f32_16x16x32_bf16 a[0:3], a[96:99], v[232:235], a[0:3]
    ds_read_b64_tr_b16 a[120:121], v16 offset:12384
    ds_read_b64_tr_b16 a[122:123], v16 offset:14448
    v_mfma_f32_16x16x32_bf16 a[4:7], a[96:99], v[236:239], a[4:7]
    v_mfma_f32_16x16x32_bf16 a[8:11], a[96:99], v[240:243], a[8:11]
    ds_write_b64 v22, a[148:149] offset:0
    ds_write_b64 v22, a[150:151] offset:8
    v_mfma_f32_16x16x32_bf16 a[20:23], a[100:103], v[240:243], a[20:23]
    ds_read_b64_tr_b16 a[124:125], v16 offset:12392
    ds_read_b64_tr_b16 a[126:127], v16 offset:14456
    v_mfma_f32_16x16x32_bf16 a[16:19], a[100:103], v[236:239], a[16:19]
    s_waitcnt vmcnt(8)
    s_barrier
    v_mfma_f32_16x16x32_bf16 a[12:15], a[100:103], v[232:235], a[12:15]
    ds_write_b64 v22, a[160:161] offset:64
    s_waitcnt lgkmcnt(13)
    v_mfma_f32_16x16x32_bf16 a[24:27], a[104:107], v[232:235], a[24:27]
    ds_read_b64_tr_b16 a[96:97], v13 offset:16896
    ds_read_b64_tr_b16 a[98:99], v13 offset:18960
    v_mfma_f32_16x16x32_bf16 a[28:31], a[104:107], v[236:239], a[28:31]
    ds_write_b64 v22, a[162:163] offset:72
    v_mfma_f32_16x16x32_bf16 a[32:35], a[104:107], v[240:243], a[32:35]
    ds_read_b128 a[172:175], v23
    ds_read_b128 a[184:187], v23 offset:1152
    v_mfma_f32_16x16x32_bf16 a[44:47], a[108:111], v[240:243], a[44:47]
    ds_read_b64_tr_b16 a[100:101], v13 offset:16904
    ds_read_b64_tr_b16 a[102:103], v13 offset:18968
    v_mfma_f32_16x16x32_bf16 a[40:43], a[108:111], v[236:239], a[40:43]
    v_mfma_f32_16x16x32_bf16 a[36:39], a[108:111], v[232:235], a[36:39]
    s_waitcnt lgkmcnt(14)
    v_mfma_f32_16x16x32_bf16 a[0:3], a[112:115], v[244:247], a[0:3]
    ds_read_b64_tr_b16 a[104:105], v16 offset:16896
    ds_read_b64_tr_b16 a[106:107], v16 offset:18960
    v_mfma_f32_16x16x32_bf16 a[4:7], a[112:115], v[248:251], a[4:7]
    s_waitcnt lgkmcnt(15)
    v_mfma_f32_16x16x32_bf16 a[8:11], a[112:115], v[252:255], a[8:11]
    buffer_store_dwordx4 a[168:171], v0, s[20:23], s54 offen offset:0 nt
    v_mfma_f32_16x16x32_bf16 a[20:23], a[116:119], v[252:255], a[20:23]
    ds_read_b64_tr_b16 a[108:109], v16 offset:16904
    ds_read_b64_tr_b16 a[110:111], v16 offset:18968
    v_mfma_f32_16x16x32_bf16 a[16:19], a[116:119], v[248:251], a[16:19]
    v_mfma_f32_16x16x32_bf16 a[12:15], a[116:119], v[244:247], a[12:15]
    ds_write_b64 v22, a[152:153] offset:0
    s_waitcnt lgkmcnt(13)
    v_mfma_f32_16x16x32_bf16 a[24:27], a[120:123], v[244:247], a[24:27]
    ds_read_b64_tr_b16 a[112:113], v13 offset:21024
    ds_read_b64_tr_b16 a[114:115], v13 offset:23088
    v_mfma_f32_16x16x32_bf16 a[28:31], a[120:123], v[248:251], a[28:31]
    ds_write_b64 v22, a[154:155] offset:8
    ds_write_b64 v22, a[164:165] offset:64
    v_mfma_f32_16x16x32_bf16 a[32:35], a[120:123], v[252:255], a[32:35]
    ds_write_b64 v22, a[166:167] offset:72
    v_mfma_f32_16x16x32_bf16 a[44:47], a[124:127], v[252:255], a[44:47]
    ds_read_b64_tr_b16 a[116:117], v13 offset:21032
    ds_read_b64_tr_b16 a[118:119], v13 offset:23096
    v_mfma_f32_16x16x32_bf16 a[40:43], a[124:127], v[248:251], a[40:43]
    ds_read_b128 a[176:179], v23
    ds_read_b128 a[188:191], v23 offset:1152
    v_mfma_f32_16x16x32_bf16 a[36:39], a[124:127], v[244:247], a[36:39]
    s_waitcnt lgkmcnt(14)
    v_mfma_f32_16x16x32_bf16 a[48:51], a[96:99], v[64:67], 0
    ds_read_b64_tr_b16 a[120:121], v16 offset:21024
    ds_read_b64_tr_b16 a[122:123], v16 offset:23088
    v_mfma_f32_16x16x32_bf16 a[52:55], a[96:99], v[68:71], 0
    v_mfma_f32_16x16x32_bf16 a[56:59], a[96:99], v[72:75], 0
    v_mfma_f32_16x16x32_bf16 a[68:71], a[100:103], v[72:75], 0
    ds_read_b64_tr_b16 a[124:125], v16 offset:21032
    ds_read_b64_tr_b16 a[126:127], v16 offset:23096
    v_mfma_f32_16x16x32_bf16 a[64:67], a[100:103], v[68:71], 0
    buffer_store_dwordx4 a[180:183], v0, s[20:23], s55 offen offset:0 nt
    v_mfma_f32_16x16x32_bf16 a[60:63], a[100:103], v[64:67], 0
    s_waitcnt lgkmcnt(14)
    s_waitcnt lgkmcnt(15)
    v_mfma_f32_16x16x32_bf16 a[72:75], a[104:107], v[64:67], 0
    ds_read_b64_tr_b16 a[96:97], v13 offset:25152
    ds_read_b64_tr_b16 a[98:99], v13 offset:27216
    v_mfma_f32_16x16x32_bf16 a[76:79], a[104:107], v[68:71], 0
    buffer_store_dwordx4 a[172:175], v0, s[20:23], s56 offen offset:0 nt
    v_mfma_f32_16x16x32_bf16 a[80:83], a[104:107], v[72:75], 0
    v_accvgpr_read_b32 v40, a0
    v_accvgpr_read_b32 v41, a1
    v_mfma_f32_16x16x32_bf16 a[92:95], a[108:111], v[72:75], 0
    ds_read_b64_tr_b16 a[100:101], v13 offset:25160
    ds_read_b64_tr_b16 a[102:103], v13 offset:27224
    v_mfma_f32_16x16x32_bf16 a[88:91], a[108:111], v[68:71], 0
    v_accvgpr_read_b32 v42, a2
    v_accvgpr_read_b32 v43, a3
    v_mfma_f32_16x16x32_bf16 a[84:87], a[108:111], v[64:67], 0
    ds_write_b64 v22, a[192:193] offset:0
    s_waitcnt lgkmcnt(11)
    v_mfma_f32_16x16x32_bf16 a[48:51], a[112:115], v[76:79], a[48:51]
    ds_read_b64_tr_b16 a[104:105], v16 offset:25152
    ds_read_b64_tr_b16 a[106:107], v16 offset:27216
    v_mfma_f32_16x16x32_bf16 a[52:55], a[112:115], v[80:83], a[52:55]
    ds_write_b64 v22, a[194:195] offset:8
    ds_write_b64 v22, a[204:205] offset:64
    v_mfma_f32_16x16x32_bf16 a[56:59], a[112:115], v[84:87], a[56:59]
    ds_write_b64 v22, a[206:207] offset:72
    v_accvgpr_read_b32 v44, a12
    v_mfma_f32_16x16x32_bf16 a[68:71], a[116:119], v[84:87], a[68:71]
    ds_read_b64_tr_b16 a[108:109], v16 offset:25160
    ds_read_b64_tr_b16 a[110:111], v16 offset:27224
    v_mfma_f32_16x16x32_bf16 a[64:67], a[116:119], v[80:83], a[64:67]
    ds_read_b128 a[216:219], v23
    ds_read_b128 a[228:231], v23 offset:1152
    v_mfma_f32_16x16x32_bf16 a[60:63], a[116:119], v[76:79], a[60:63]
    v_accvgpr_read_b32 v45, a13
    s_waitcnt lgkmcnt(14)
    v_mfma_f32_16x16x32_bf16 a[72:75], a[120:123], v[76:79], a[72:75]
    ds_read_b64_tr_b16 a[112:113], v13 offset:29280
    ds_read_b64_tr_b16 a[114:115], v13 offset:31344
    v_mfma_f32_16x16x32_bf16 a[76:79], a[120:123], v[80:83], a[76:79]
    v_accvgpr_read_b32 v46, a14
    s_waitcnt lgkmcnt(15)
    v_mfma_f32_16x16x32_bf16 a[80:83], a[120:123], v[84:87], a[80:83]
    buffer_store_dwordx4 a[184:187], v0, s[20:23], s57 offen offset:0 nt
    v_mfma_f32_16x16x32_bf16 a[92:95], a[124:127], v[84:87], a[92:95]
    ds_read_b64_tr_b16 a[116:117], v13 offset:29288
    ds_read_b64_tr_b16 a[118:119], v13 offset:31352
    v_mfma_f32_16x16x32_bf16 a[88:91], a[124:127], v[80:83], a[88:91]
    buffer_store_dwordx4 a[176:179], v0, s[20:23], s58 offen offset:0 nt
    v_mfma_f32_16x16x32_bf16 a[84:87], a[124:127], v[76:79], a[84:87]
    v_accvgpr_read_b32 v47, a15
    s_waitcnt lgkmcnt(14)
    v_mfma_f32_16x16x32_bf16 a[48:51], a[96:99], v[88:91], a[48:51]
    ds_read_b64_tr_b16 a[120:121], v16 offset:29280
    ds_read_b64_tr_b16 a[122:123], v16 offset:31344
    v_mfma_f32_16x16x32_bf16 a[52:55], a[96:99], v[92:95], a[52:55]
    v_mul_f32 v40, v28, v40
    v_mul_f32 v41, v28, v41
    v_mfma_f32_16x16x32_bf16 a[56:59], a[96:99], v[96:99], a[56:59]
    ds_write_b64 v22, a[196:197] offset:0
    ds_write_b64 v22, a[198:199] offset:8
    v_mfma_f32_16x16x32_bf16 a[68:71], a[100:103], v[96:99], a[68:71]
    ds_read_b64_tr_b16 a[124:125], v16 offset:29288
    ds_read_b64_tr_b16 a[126:127], v16 offset:31352
    v_mfma_f32_16x16x32_bf16 a[64:67], a[100:103], v[92:95], a[64:67]
    ds_write_b64 v22, a[208:209] offset:64
    ds_write_b64 v22, a[210:211] offset:72
    v_mfma_f32_16x16x32_bf16 a[60:63], a[100:103], v[88:91], a[60:63]
    ds_read_b128 a[220:223], v23
    s_waitcnt lgkmcnt(15)
    v_mfma_f32_16x16x32_bf16 a[72:75], a[104:107], v[88:91], a[72:75]
    ds_read_b64_tr_b16 a[96:97], v13 offset:33792
    ds_read_b64_tr_b16 a[98:99], v13 offset:35856
    v_mfma_f32_16x16x32_bf16 a[76:79], a[104:107], v[92:95], a[76:79]
    ds_read_b128 a[232:235], v23 offset:1152
    v_mul_f32 v42, v28, v42
    v_mfma_f32_16x16x32_bf16 a[80:83], a[104:107], v[96:99], a[80:83]
    v_mul_f32 v43, v28, v43
    v_mul_f32 v44, v28, v44
    v_mfma_f32_16x16x32_bf16 a[92:95], a[108:111], v[96:99], a[92:95]
    ds_read_b64_tr_b16 a[100:101], v13 offset:33800
    ds_read_b64_tr_b16 a[102:103], v13 offset:35864
    v_mfma_f32_16x16x32_bf16 a[88:91], a[108:111], v[92:95], a[88:91]
    v_mul_f32 v45, v28, v45
    v_mul_f32 v46, v28, v46
    v_mfma_f32_16x16x32_bf16 a[84:87], a[108:111], v[88:91], a[84:87]
    v_mul_f32 v47, v28, v47
    s_waitcnt lgkmcnt(14)
    v_mfma_f32_16x16x32_bf16 a[48:51], a[112:115], v[100:103], a[48:51]
    ds_read_b64_tr_b16 a[104:105], v16 offset:33792
    ds_read_b64_tr_b16 a[106:107], v16 offset:35856
    v_mfma_f32_16x16x32_bf16 a[52:55], a[112:115], v[104:107], a[52:55]
    buffer_store_dwordx4 a[188:191], v0, s[20:23], s59 offen offset:0 nt
    v_mfma_f32_16x16x32_bf16 a[56:59], a[112:115], v[108:111], a[56:59]
    v_cvt_pk_bf16_f32 v56, v40, v41
    s_waitcnt lgkmcnt(15)
    v_mfma_f32_16x16x32_bf16 a[68:71], a[116:119], v[108:111], a[68:71]
    ds_read_b64_tr_b16 a[108:109], v16 offset:33800
    ds_read_b64_tr_b16 a[110:111], v16 offset:35864
    v_mfma_f32_16x16x32_bf16 a[64:67], a[116:119], v[104:107], a[64:67]
    buffer_store_dwordx4 a[216:219], v0, s[20:23], s54 offen offset:128 nt
    v_mfma_f32_16x16x32_bf16 a[60:63], a[116:119], v[100:103], a[60:63]
    ds_write_b64 v22, a[200:201] offset:0
    s_waitcnt lgkmcnt(13)
    v_mfma_f32_16x16x32_bf16 a[72:75], a[120:123], v[100:103], a[72:75]
    ds_read_b64_tr_b16 a[112:113], v13 offset:37920
    ds_read_b64_tr_b16 a[114:115], v13 offset:39984
    v_mfma_f32_16x16x32_bf16 a[76:79], a[120:123], v[104:107], a[76:79]
    ds_write_b64 v22, a[202:203] offset:8
    ds_write_b64 v22, a[212:213] offset:64
    v_mfma_f32_16x16x32_bf16 a[80:83], a[120:123], v[108:111], a[80:83]
    ds_write_b64 v22, a[214:215] offset:72
    v_cvt_pk_bf16_f32 v57, v42, v43
    v_mfma_f32_16x16x32_bf16 a[92:95], a[124:127], v[108:111], a[92:95]
    ds_read_b64_tr_b16 a[116:117], v13 offset:37928
    ds_read_b64_tr_b16 a[118:119], v13 offset:39992
    v_mfma_f32_16x16x32_bf16 a[88:91], a[124:127], v[104:107], a[88:91]
    ds_read_b128 a[224:227], v23
    ds_read_b128 a[236:239], v23 offset:1152
    v_mfma_f32_16x16x32_bf16 a[84:87], a[124:127], v[100:103], a[84:87]
    v_cvt_pk_bf16_f32 v58, v44, v45
    s_waitcnt lgkmcnt(14)
    v_mfma_f32_16x16x32_bf16 a[48:51], a[96:99], v[112:115], a[48:51]
    ds_read_b64_tr_b16 a[120:121], v16 offset:37920
    ds_read_b64_tr_b16 a[122:123], v16 offset:39984
    v_mfma_f32_16x16x32_bf16 a[52:55], a[96:99], v[116:119], a[52:55]
    v_cvt_pk_bf16_f32 v59, v46, v47
    v_accvgpr_read_b32 v40, a24
    v_mfma_f32_16x16x32_bf16 a[56:59], a[96:99], v[120:123], a[56:59]
    v_accvgpr_read_b32 v41, a25
    v_accvgpr_read_b32 v42, a26
    v_mfma_f32_16x16x32_bf16 a[68:71], a[100:103], v[120:123], a[68:71]
    ds_read_b64_tr_b16 a[124:125], v16 offset:37928
    ds_read_b64_tr_b16 a[126:127], v16 offset:39992
    v_mfma_f32_16x16x32_bf16 a[64:67], a[100:103], v[116:119], a[64:67]
    v_accvgpr_read_b32 v43, a27
    s_waitcnt lgkmcnt(15)
    v_mfma_f32_16x16x32_bf16 a[60:63], a[100:103], v[112:115], a[60:63]
    v_accvgpr_read_b32 v44, a36
    s_waitcnt lgkmcnt(14)
    v_mfma_f32_16x16x32_bf16 a[72:75], a[104:107], v[112:115], a[72:75]
    ds_read_b64_tr_b16 a[96:97], v13 offset:42048
    ds_read_b64_tr_b16 a[98:99], v13 offset:44112
    v_mfma_f32_16x16x32_bf16 a[76:79], a[104:107], v[116:119], a[76:79]
    buffer_store_dwordx4 a[228:231], v0, s[20:23], s55 offen offset:128 nt
    v_mfma_f32_16x16x32_bf16 a[80:83], a[104:107], v[120:123], a[80:83]
    buffer_store_dwordx4 a[220:223], v0, s[20:23], s56 offen offset:128 nt
    v_mfma_f32_16x16x32_bf16 a[92:95], a[108:111], v[120:123], a[92:95]
    ds_read_b64_tr_b16 a[100:101], v13 offset:42056
    ds_read_b64_tr_b16 a[102:103], v13 offset:44120
    v_mfma_f32_16x16x32_bf16 a[88:91], a[108:111], v[116:119], a[88:91]
    v_accvgpr_read_b32 v45, a37
    v_accvgpr_read_b32 v46, a38
    v_mfma_f32_16x16x32_bf16 a[84:87], a[108:111], v[112:115], a[84:87]
    v_accvgpr_read_b32 v47, a39
    s_waitcnt lgkmcnt(10)
    v_mfma_f32_16x16x32_bf16 a[48:51], a[112:115], v[124:127], a[48:51]
    ds_read_b64_tr_b16 a[104:105], v16 offset:42048
    ds_read_b64_tr_b16 a[106:107], v16 offset:44112
    v_mfma_f32_16x16x32_bf16 a[52:55], a[112:115], v[128:131], a[52:55]
    v_mul_f32 v40, v28, v40
    v_mul_f32 v41, v28, v41
    v_mfma_f32_16x16x32_bf16 a[56:59], a[112:115], v[132:135], a[56:59]
    v_mul_f32 v42, v28, v42
    v_mul_f32 v43, v28, v43
    v_mfma_f32_16x16x32_bf16 a[68:71], a[116:119], v[132:135], a[68:71]
    ds_read_b64_tr_b16 a[108:109], v16 offset:42056
    ds_read_b64_tr_b16 a[110:111], v16 offset:44120
    v_mfma_f32_16x16x32_bf16 a[64:67], a[116:119], v[128:131], a[64:67]
    v_mul_f32 v44, v28, v44
    v_mul_f32 v45, v28, v45
    v_mfma_f32_16x16x32_bf16 a[60:63], a[116:119], v[124:127], a[60:63]
    v_mul_f32 v46, v28, v46
    s_waitcnt lgkmcnt(8)
    v_mfma_f32_16x16x32_bf16 a[72:75], a[120:123], v[124:127], a[72:75]
    ds_read_b64_tr_b16 a[112:113], v13 offset:46176
    ds_read_b64_tr_b16 a[114:115], v13 offset:48240
    v_mfma_f32_16x16x32_bf16 a[76:79], a[120:123], v[128:131], a[76:79]
    v_mul_f32 v47, v28, v47
    s_waitcnt lgkmcnt(14)
    v_mfma_f32_16x16x32_bf16 a[80:83], a[120:123], v[132:135], a[80:83]
    buffer_store_dwordx4 a[224:227], v0, s[20:23], s58 offen offset:128 nt
    v_mfma_f32_16x16x32_bf16 a[92:95], a[124:127], v[132:135], a[92:95]
    ds_read_b64_tr_b16 a[116:117], v13 offset:46184
    ds_read_b64_tr_b16 a[118:119], v13 offset:48248
    v_mfma_f32_16x16x32_bf16 a[88:91], a[124:127], v[128:131], a[88:91]
    buffer_store_dwordx4 a[232:235], v0, s[20:23], s57 offen offset:128 nt
    v_mfma_f32_16x16x32_bf16 a[84:87], a[124:127], v[124:127], a[84:87]
    v_cvt_pk_bf16_f32 v60, v40, v41
    s_waitcnt lgkmcnt(8)
    v_mfma_f32_16x16x32_bf16 a[48:51], a[96:99], v[136:139], a[48:51]
    ds_read_b64_tr_b16 a[120:121], v16 offset:46176
    ds_read_b64_tr_b16 a[122:123], v16 offset:48240
    v_mfma_f32_16x16x32_bf16 a[52:55], a[96:99], v[140:143], a[52:55]
    v_cvt_pk_bf16_f32 v61, v42, v43
    v_cvt_pk_bf16_f32 v62, v44, v45
    v_mfma_f32_16x16x32_bf16 a[56:59], a[96:99], v[144:147], a[56:59]
    v_cvt_pk_bf16_f32 v63, v46, v47
    v_mfma_f32_16x16x32_bf16 a[68:71], a[100:103], v[144:147], a[68:71]
    ds_read_b64_tr_b16 a[124:125], v16 offset:46184
    ds_read_b64_tr_b16 a[126:127], v16 offset:48248
    v_mfma_f32_16x16x32_bf16 a[64:67], a[100:103], v[140:143], a[64:67]
    s_waitcnt vmcnt(11)
    s_barrier
    v_mfma_f32_16x16x32_bf16 a[60:63], a[100:103], v[136:139], a[60:63]
    ds_write_b64 v22, v[56:57] offset:0
    s_waitcnt lgkmcnt(9)
    v_mfma_f32_16x16x32_bf16 a[72:75], a[104:107], v[136:139], a[72:75]
    ds_read_b64_tr_b16 a[96:97], v14 offset:0
    ds_read_b64_tr_b16 a[98:99], v14 offset:2064
    v_mfma_f32_16x16x32_bf16 a[76:79], a[104:107], v[140:143], a[76:79]
    ds_write_b64 v22, v[58:59] offset:8
    ds_write_b64 v22, v[60:61] offset:64
    v_mfma_f32_16x16x32_bf16 a[80:83], a[104:107], v[144:147], a[80:83]
    ds_write_b64 v22, v[62:63] offset:72
    v_accvgpr_read_b32 v40, a4
    v_mfma_f32_16x16x32_bf16 a[92:95], a[108:111], v[144:147], a[92:95]
    ds_read_b64_tr_b16 a[100:101], v14 offset:8
    ds_read_b64_tr_b16 a[102:103], v14 offset:2072
    v_mfma_f32_16x16x32_bf16 a[88:91], a[108:111], v[140:143], a[88:91]
    buffer_store_dwordx4 a[236:239], v0, s[20:23], s59 offen offset:128 nt
    v_mfma_f32_16x16x32_bf16 a[84:87], a[108:111], v[136:139], a[84:87]
    ds_read_b128 v[56:59], v23
    s_waitcnt lgkmcnt(13)
    v_mfma_f32_16x16x32_bf16 a[48:51], a[112:115], v[148:151], a[48:51]
    ds_read_b64_tr_b16 a[104:105], v17 offset:0
    ds_read_b64_tr_b16 a[106:107], v17 offset:2064
    v_mfma_f32_16x16x32_bf16 a[52:55], a[112:115], v[152:155], a[52:55]
    ds_read_b128 v[60:63], v23 offset:1152
    v_accvgpr_read_b32 v41, a5
    v_mfma_f32_16x16x32_bf16 a[56:59], a[112:115], v[156:159], a[56:59]
    v_accvgpr_read_b32 v42, a6
    v_accvgpr_read_b32 v43, a7
    v_mfma_f32_16x16x32_bf16 a[68:71], a[116:119], v[156:159], a[68:71]
    ds_read_b64_tr_b16 a[108:109], v17 offset:8
    ds_read_b64_tr_b16 a[110:111], v17 offset:2072
    v_mfma_f32_16x16x32_bf16 a[64:67], a[116:119], v[152:155], a[64:67]
    v_accvgpr_read_b32 v44, a16
    v_accvgpr_read_b32 v45, a17
    v_mfma_f32_16x16x32_bf16 a[60:63], a[116:119], v[148:151], a[60:63]
    v_accvgpr_read_b32 v46, a18
    s_waitcnt lgkmcnt(14)
    v_mfma_f32_16x16x32_bf16 a[72:75], a[120:123], v[148:151], a[72:75]
    ds_read_b64_tr_b16 a[112:113], v14 offset:4128
    ds_read_b64_tr_b16 a[114:115], v14 offset:6192
    v_mfma_f32_16x16x32_bf16 a[76:79], a[120:123], v[152:155], a[76:79]
    v_accvgpr_read_b32 v47, a19
    v_mul_f32 v40, v29, v40
    v_mfma_f32_16x16x32_bf16 a[80:83], a[120:123], v[156:159], a[80:83]
    v_mul_f32 v41, v29, v41
    v_mul_f32 v42, v29, v42
    v_mfma_f32_16x16x32_bf16 a[92:95], a[124:127], v[156:159], a[92:95]
    ds_read_b64_tr_b16 a[116:117], v14 offset:4136
    ds_read_b64_tr_b16 a[118:119], v14 offset:6200
    v_mfma_f32_16x16x32_bf16 a[88:91], a[124:127], v[152:155], a[88:91]
    v_mul_f32 v43, v29, v43
    v_mul_f32 v44, v29, v44
    v_mfma_f32_16x16x32_bf16 a[84:87], a[124:127], v[148:151], a[84:87]
    v_mul_f32 v45, v29, v45
    s_waitcnt lgkmcnt(10)
    v_mfma_f32_16x16x32_bf16 a[48:51], a[96:99], v[160:163], a[48:51]
    ds_read_b64_tr_b16 a[120:121], v17 offset:4128
    ds_read_b64_tr_b16 a[122:123], v17 offset:6192
    v_mfma_f32_16x16x32_bf16 a[52:55], a[96:99], v[164:167], a[52:55]
    v_mul_f32 v46, v29, v46
    v_mul_f32 v47, v29, v47
    v_mfma_f32_16x16x32_bf16 a[56:59], a[96:99], v[168:171], a[56:59]
    v_cvt_pk_bf16_f32 v32, v40, v41
    v_cvt_pk_bf16_f32 v33, v42, v43
    v_mfma_f32_16x16x32_bf16 a[68:71], a[100:103], v[168:171], a[68:71]
    ds_read_b64_tr_b16 a[124:125], v17 offset:4136
    ds_read_b64_tr_b16 a[126:127], v17 offset:6200
    v_mfma_f32_16x16x32_bf16 a[64:67], a[100:103], v[164:167], a[64:67]
    v_cvt_pk_bf16_f32 v34, v44, v45
    v_cvt_pk_bf16_f32 v35, v46, v47
    v_mfma_f32_16x16x32_bf16 a[60:63], a[100:103], v[160:163], a[60:63]
    v_accvgpr_read_b32 v40, a28
    s_waitcnt lgkmcnt(8)
    v_mfma_f32_16x16x32_bf16 a[72:75], a[104:107], v[160:163], a[72:75]
    ds_read_b64_tr_b16 a[96:97], v14 offset:8256
    ds_read_b64_tr_b16 a[98:99], v14 offset:10320
    v_mfma_f32_16x16x32_bf16 a[76:79], a[104:107], v[164:167], a[76:79]
    v_accvgpr_read_b32 v41, a29
    v_accvgpr_read_b32 v42, a30
    v_mfma_f32_16x16x32_bf16 a[80:83], a[104:107], v[168:171], a[80:83]
    v_accvgpr_read_b32 v43, a31
    v_accvgpr_read_b32 v44, a40
    v_mfma_f32_16x16x32_bf16 a[92:95], a[108:111], v[168:171], a[92:95]
    ds_read_b64_tr_b16 a[100:101], v14 offset:8264
    ds_read_b64_tr_b16 a[102:103], v14 offset:10328
    v_mfma_f32_16x16x32_bf16 a[88:91], a[108:111], v[164:167], a[88:91]
    v_accvgpr_read_b32 v45, a41
    s_waitcnt lgkmcnt(14)
    v_mfma_f32_16x16x32_bf16 a[84:87], a[108:111], v[160:163], a[84:87]
    v_accvgpr_read_b32 v46, a42
    s_waitcnt lgkmcnt(8)
    v_mfma_f32_16x16x32_bf16 a[48:51], a[112:115], v[172:175], a[48:51]
    ds_read_b64_tr_b16 a[104:105], v17 offset:8256
    ds_read_b64_tr_b16 a[106:107], v17 offset:10320
    v_mfma_f32_16x16x32_bf16 a[52:55], a[112:115], v[176:179], a[52:55]
    buffer_store_dwordx4 v[56:59], v0, s[20:23], s54 offen offset:256 nt
    v_mfma_f32_16x16x32_bf16 a[56:59], a[112:115], v[180:183], a[56:59]
    v_accvgpr_read_b32 v47, a43
    v_mul_f32 v40, v29, v40
    v_mfma_f32_16x16x32_bf16 a[68:71], a[116:119], v[180:183], a[68:71]
    ds_read_b64_tr_b16 a[108:109], v17 offset:8264
    ds_read_b64_tr_b16 a[110:111], v17 offset:10328
    v_mfma_f32_16x16x32_bf16 a[64:67], a[116:119], v[176:179], a[64:67]
    v_mul_f32 v41, v29, v41
    v_mul_f32 v42, v29, v42
    v_mfma_f32_16x16x32_bf16 a[60:63], a[116:119], v[172:175], a[60:63]
    v_mul_f32 v43, v29, v43
    s_waitcnt lgkmcnt(8)
    v_mfma_f32_16x16x32_bf16 a[72:75], a[120:123], v[172:175], a[72:75]
    ds_read_b64_tr_b16 a[112:113], v14 offset:12384
    ds_read_b64_tr_b16 a[114:115], v14 offset:14448
    v_mfma_f32_16x16x32_bf16 a[76:79], a[120:123], v[176:179], a[76:79]
    v_mul_f32 v44, v29, v44
    v_mul_f32 v45, v29, v45
    v_mfma_f32_16x16x32_bf16 a[80:83], a[120:123], v[180:183], a[80:83]
    v_mul_f32 v46, v29, v46
    v_mul_f32 v47, v29, v47
    v_mfma_f32_16x16x32_bf16 a[92:95], a[124:127], v[180:183], a[92:95]
    ds_read_b64_tr_b16 a[116:117], v14 offset:12392
    ds_read_b64_tr_b16 a[118:119], v14 offset:14456
    v_mfma_f32_16x16x32_bf16 a[88:91], a[124:127], v[176:179], a[88:91]
    v_cvt_pk_bf16_f32 v36, v40, v41
    v_cvt_pk_bf16_f32 v37, v42, v43
    v_mfma_f32_16x16x32_bf16 a[84:87], a[124:127], v[172:175], a[84:87]
    v_cvt_pk_bf16_f32 v38, v44, v45
    s_waitcnt lgkmcnt(8)
    v_mfma_f32_16x16x32_bf16 a[48:51], a[96:99], v[184:187], a[48:51]
    ds_read_b64_tr_b16 a[120:121], v17 offset:12384
    ds_read_b64_tr_b16 a[122:123], v17 offset:14448
    v_mfma_f32_16x16x32_bf16 a[52:55], a[96:99], v[188:191], a[52:55]
    v_cvt_pk_bf16_f32 v39, v46, v47
    v_mfma_f32_16x16x32_bf16 a[56:59], a[96:99], v[192:195], a[56:59]
    buffer_store_dwordx4 v[60:63], v0, s[20:23], s55 offen offset:256 nt
    v_mfma_f32_16x16x32_bf16 a[68:71], a[100:103], v[192:195], a[68:71]
    ds_read_b64_tr_b16 a[124:125], v17 offset:12392
    ds_read_b64_tr_b16 a[126:127], v17 offset:14456
    v_mfma_f32_16x16x32_bf16 a[64:67], a[100:103], v[188:191], a[64:67]
    ds_write_b64 v22, v[32:33] offset:0
    ds_write_b64 v22, v[34:35] offset:8
    v_mfma_f32_16x16x32_bf16 a[60:63], a[100:103], v[184:187], a[60:63]
    ds_write_b64 v22, v[36:37] offset:64
    s_waitcnt lgkmcnt(11)
    v_mfma_f32_16x16x32_bf16 a[72:75], a[104:107], v[184:187], a[72:75]
    ds_read_b64_tr_b16 a[96:97], v14 offset:16896
    ds_read_b64_tr_b16 a[98:99], v14 offset:18960
    v_mfma_f32_16x16x32_bf16 a[76:79], a[104:107], v[188:191], a[76:79]
    ds_write_b64 v22, v[38:39] offset:72
    v_accvgpr_read_b32 v40, a8
    v_mfma_f32_16x16x32_bf16 a[80:83], a[104:107], v[192:195], a[80:83]
    ds_read_b128 v[32:35], v23
    ds_read_b128 v[36:39], v23 offset:1152
    v_mfma_f32_16x16x32_bf16 a[92:95], a[108:111], v[192:195], a[92:95]
    ds_read_b64_tr_b16 a[100:101], v14 offset:16904
    ds_read_b64_tr_b16 a[102:103], v14 offset:18968
    v_mfma_f32_16x16x32_bf16 a[88:91], a[108:111], v[188:191], a[88:91]
    v_accvgpr_read_b32 v41, a9
    v_accvgpr_read_b32 v42, a10
    v_mfma_f32_16x16x32_bf16 a[84:87], a[108:111], v[184:187], a[84:87]
    v_accvgpr_read_b32 v43, a11
    s_waitcnt lgkmcnt(14)
    v_mfma_f32_16x16x32_bf16 a[48:51], a[112:115], v[196:199], a[48:51]
    ds_read_b64_tr_b16 a[104:105], v17 offset:16896
    ds_read_b64_tr_b16 a[106:107], v17 offset:18960
    v_mfma_f32_16x16x32_bf16 a[52:55], a[112:115], v[200:203], a[52:55]
    v_accvgpr_read_b32 v44, a20
    v_accvgpr_read_b32 v45, a21
    v_mfma_f32_16x16x32_bf16 a[56:59], a[112:115], v[204:207], a[56:59]
    v_accvgpr_read_b32 v46, a22
    v_accvgpr_read_b32 v47, a23
    v_mfma_f32_16x16x32_bf16 a[68:71], a[116:119], v[204:207], a[68:71]
    ds_read_b64_tr_b16 a[108:109], v17 offset:16904
    ds_read_b64_tr_b16 a[110:111], v17 offset:18968
    v_mfma_f32_16x16x32_bf16 a[64:67], a[116:119], v[200:203], a[64:67]
    v_mul_f32 v40, v30, v40
    v_mul_f32 v41, v30, v41
    v_mfma_f32_16x16x32_bf16 a[60:63], a[116:119], v[196:199], a[60:63]
    v_mul_f32 v42, v30, v42
    s_waitcnt lgkmcnt(14)
    v_mfma_f32_16x16x32_bf16 a[72:75], a[120:123], v[196:199], a[72:75]
    ds_read_b64_tr_b16 a[112:113], v14 offset:21024
    ds_read_b64_tr_b16 a[114:115], v14 offset:23088
    v_mfma_f32_16x16x32_bf16 a[76:79], a[120:123], v[200:203], a[76:79]
    v_mul_f32 v43, v30, v43
    v_mul_f32 v44, v30, v44
    v_mfma_f32_16x16x32_bf16 a[80:83], a[120:123], v[204:207], a[80:83]
    v_mul_f32 v45, v30, v45
    v_mul_f32 v46, v30, v46
    v_mfma_f32_16x16x32_bf16 a[92:95], a[124:127], v[204:207], a[92:95]
    ds_read_b64_tr_b16 a[116:117], v14 offset:21032
    ds_read_b64_tr_b16 a[118:119], v14 offset:23096
    v_mfma_f32_16x16x32_bf16 a[88:91], a[124:127], v[200:203], a[88:91]
    v_mul_f32 v47, v30, v47
    v_cvt_pk_bf16_f32 v48, v40, v41
    v_mfma_f32_16x16x32_bf16 a[84:87], a[124:127], v[196:199], a[84:87]
    v_cvt_pk_bf16_f32 v49, v42, v43
    s_waitcnt lgkmcnt(8)
    v_mfma_f32_16x16x32_bf16 a[48:51], a[96:99], v[208:211], a[48:51]
    ds_read_b64_tr_b16 a[120:121], v17 offset:21024
    ds_read_b64_tr_b16 a[122:123], v17 offset:23088
    v_mfma_f32_16x16x32_bf16 a[52:55], a[96:99], v[212:215], a[52:55]
    v_cvt_pk_bf16_f32 v50, v44, v45
    v_cvt_pk_bf16_f32 v51, v46, v47
    v_mfma_f32_16x16x32_bf16 a[56:59], a[96:99], v[216:219], a[56:59]
    v_accvgpr_read_b32 v40, a32
    v_accvgpr_read_b32 v41, a33
    v_mfma_f32_16x16x32_bf16 a[68:71], a[100:103], v[216:219], a[68:71]
    ds_read_b64_tr_b16 a[124:125], v17 offset:21032
    ds_read_b64_tr_b16 a[126:127], v17 offset:23096
    v_mfma_f32_16x16x32_bf16 a[64:67], a[100:103], v[212:215], a[64:67]
    v_accvgpr_read_b32 v42, a34
    v_accvgpr_read_b32 v43, a35
    v_mfma_f32_16x16x32_bf16 a[60:63], a[100:103], v[208:211], a[60:63]
    s_waitcnt lgkmcnt(8)
    s_waitcnt lgkmcnt(14)
    v_mfma_f32_16x16x32_bf16 a[72:75], a[104:107], v[208:211], a[72:75]
    ds_read_b64_tr_b16 a[96:97], v14 offset:25152
    ds_read_b64_tr_b16 a[98:99], v14 offset:27216
    v_mfma_f32_16x16x32_bf16 a[76:79], a[104:107], v[212:215], a[76:79]
    buffer_store_dwordx4 v[32:35], v0, s[20:23], s56 offen offset:256 nt
    v_mfma_f32_16x16x32_bf16 a[80:83], a[104:107], v[216:219], a[80:83]
    v_accvgpr_read_b32 v44, a44
    v_accvgpr_read_b32 v45, a45
    v_mfma_f32_16x16x32_bf16 a[92:95], a[108:111], v[216:219], a[92:95]
    ds_read_b64_tr_b16 a[100:101], v14 offset:25160
    ds_read_b64_tr_b16 a[102:103], v14 offset:27224
    v_mfma_f32_16x16x32_bf16 a[88:91], a[108:111], v[212:215], a[88:91]
    v_accvgpr_read_b32 v46, a46
    v_accvgpr_read_b32 v47, a47
    v_mfma_f32_16x16x32_bf16 a[84:87], a[108:111], v[208:211], a[84:87]
    v_mul_f32 v40, v30, v40
    s_waitcnt lgkmcnt(8)
    v_mfma_f32_16x16x32_bf16 a[48:51], a[112:115], v[220:223], a[48:51]
    ds_read_b64_tr_b16 a[104:105], v17 offset:25152
    ds_read_b64_tr_b16 a[106:107], v17 offset:27216
    v_mfma_f32_16x16x32_bf16 a[52:55], a[112:115], v[224:227], a[52:55]
    v_mul_f32 v41, v30, v41
    v_mul_f32 v42, v30, v42
    v_mfma_f32_16x16x32_bf16 a[56:59], a[112:115], v[228:231], a[56:59]
    v_mul_f32 v43, v30, v43
    v_mul_f32 v44, v30, v44
    v_mfma_f32_16x16x32_bf16 a[68:71], a[116:119], v[228:231], a[68:71]
    ds_read_b64_tr_b16 a[108:109], v17 offset:25160
    ds_read_b64_tr_b16 a[110:111], v17 offset:27224
    v_mfma_f32_16x16x32_bf16 a[64:67], a[116:119], v[224:227], a[64:67]
    v_mul_f32 v45, v30, v45
    v_mul_f32 v46, v30, v46
    v_mfma_f32_16x16x32_bf16 a[60:63], a[116:119], v[220:223], a[60:63]
    v_mul_f32 v47, v30, v47
    s_waitcnt lgkmcnt(8)
    v_mfma_f32_16x16x32_bf16 a[72:75], a[120:123], v[220:223], a[72:75]
    ds_read_b64_tr_b16 a[112:113], v14 offset:29280
    ds_read_b64_tr_b16 a[114:115], v14 offset:31344
    v_mfma_f32_16x16x32_bf16 a[76:79], a[120:123], v[224:227], a[76:79]
    v_cvt_pk_bf16_f32 v52, v40, v41
    v_cvt_pk_bf16_f32 v53, v42, v43
    v_mfma_f32_16x16x32_bf16 a[80:83], a[120:123], v[228:231], a[80:83]
    buffer_store_dwordx4 v[36:39], v0, s[20:23], s57 offen offset:256 nt
    v_mfma_f32_16x16x32_bf16 a[92:95], a[124:127], v[228:231], a[92:95]
    ds_read_b64_tr_b16 a[116:117], v14 offset:29288
    ds_read_b64_tr_b16 a[118:119], v14 offset:31352
    v_mfma_f32_16x16x32_bf16 a[88:91], a[124:127], v[224:227], a[88:91]
    v_cvt_pk_bf16_f32 v54, v44, v45
    v_cvt_pk_bf16_f32 v55, v46, v47
    v_mfma_f32_16x16x32_bf16 a[84:87], a[124:127], v[220:223], a[84:87]
    ds_write_b64 v22, v[48:49] offset:0
    s_waitcnt lgkmcnt(9)
    v_mfma_f32_16x16x32_bf16 a[48:51], a[96:99], v[232:235], a[48:51]
    ds_read_b64_tr_b16 a[120:121], v17 offset:29280
    ds_read_b64_tr_b16 a[122:123], v17 offset:31344
    v_mfma_f32_16x16x32_bf16 a[52:55], a[96:99], v[236:239], a[52:55]
    ds_write_b64 v22, v[50:51] offset:8
    ds_write_b64 v22, v[52:53] offset:64
    v_mfma_f32_16x16x32_bf16 a[56:59], a[96:99], v[240:243], a[56:59]
    ds_write_b64 v22, v[54:55] offset:72
    v_mfma_f32_16x16x32_bf16 a[68:71], a[100:103], v[240:243], a[68:71]
    ds_read_b64_tr_b16 a[124:125], v17 offset:29288
    ds_read_b64_tr_b16 a[126:127], v17 offset:31352
    v_mfma_f32_16x16x32_bf16 a[64:67], a[100:103], v[236:239], a[64:67]
    ds_read_b128 v[48:51], v23
    ds_read_b128 v[52:55], v23 offset:1152
    v_mfma_f32_16x16x32_bf16 a[60:63], a[100:103], v[232:235], a[60:63]
    s_waitcnt lgkmcnt(14)
    v_mfma_f32_16x16x32_bf16 a[72:75], a[104:107], v[232:235], a[72:75]
    v_mfma_f32_16x16x32_bf16 a[76:79], a[104:107], v[236:239], a[76:79]
    v_mfma_f32_16x16x32_bf16 a[80:83], a[104:107], v[240:243], a[80:83]
    v_mfma_f32_16x16x32_bf16 a[92:95], a[108:111], v[240:243], a[92:95]
    v_mfma_f32_16x16x32_bf16 a[88:91], a[108:111], v[236:239], a[88:91]
    v_mfma_f32_16x16x32_bf16 a[84:87], a[108:111], v[232:235], a[84:87]
    s_waitcnt lgkmcnt(10)
    v_mfma_f32_16x16x32_bf16 a[48:51], a[112:115], v[244:247], a[48:51]
    v_mfma_f32_16x16x32_bf16 a[52:55], a[112:115], v[248:251], a[52:55]
    v_mfma_f32_16x16x32_bf16 a[56:59], a[112:115], v[252:255], a[56:59]
    v_mfma_f32_16x16x32_bf16 a[68:71], a[116:119], v[252:255], a[68:71]
    v_mfma_f32_16x16x32_bf16 a[64:67], a[116:119], v[248:251], a[64:67]
    v_mfma_f32_16x16x32_bf16 a[60:63], a[116:119], v[244:247], a[60:63]
    s_waitcnt lgkmcnt(2)
    v_mfma_f32_16x16x32_bf16 a[72:75], a[120:123], v[244:247], a[72:75]
    v_mfma_f32_16x16x32_bf16 a[76:79], a[120:123], v[248:251], a[76:79]
    v_mfma_f32_16x16x32_bf16 a[80:83], a[120:123], v[252:255], a[80:83]
    v_mfma_f32_16x16x32_bf16 a[92:95], a[124:127], v[252:255], a[92:95]
    v_mfma_f32_16x16x32_bf16 a[88:91], a[124:127], v[248:251], a[88:91]
    v_mfma_f32_16x16x32_bf16 a[84:87], a[124:127], v[244:247], a[84:87]
    s_nop 7
    s_waitcnt lgkmcnt(0)
    buffer_store_dwordx4 v[48:51], v0, s[20:23], s58 offen offset:256 nt
    buffer_store_dwordx4 v[52:55], v0, s[20:23], s59 offen offset:256 nt
    v_accvgpr_read_b32 v64, a48
    v_accvgpr_read_b32 v65, a49
    v_accvgpr_read_b32 v66, a50
    v_accvgpr_read_b32 v67, a51
    v_accvgpr_read_b32 v68, a60
    v_accvgpr_read_b32 v69, a61
    v_accvgpr_read_b32 v70, a62
    v_accvgpr_read_b32 v71, a63
    v_pk_mul_f32 v[64:65], v[64:65], v[28:29] op_sel_hi:[1,0]
    v_pk_mul_f32 v[66:67], v[66:67], v[28:29] op_sel_hi:[1,0]
    v_pk_mul_f32 v[68:69], v[68:69], v[28:29] op_sel_hi:[1,0]
    v_pk_mul_f32 v[70:71], v[70:71], v[28:29] op_sel_hi:[1,0]
    v_cvt_pk_bf16_f32 v72, v64, v65
    v_cvt_pk_bf16_f32 v73, v66, v67
    v_cvt_pk_bf16_f32 v74, v68, v69
    v_cvt_pk_bf16_f32 v75, v70, v71
    ds_write_b64 v22, v[72:73] offset:0
    ds_write_b64 v22, v[74:75] offset:8
    v_accvgpr_read_b32 v64, a72
    v_accvgpr_read_b32 v65, a73
    v_accvgpr_read_b32 v66, a74
    v_accvgpr_read_b32 v67, a75
    v_accvgpr_read_b32 v68, a84
    v_accvgpr_read_b32 v69, a85
    v_accvgpr_read_b32 v70, a86
    v_accvgpr_read_b32 v71, a87
    v_pk_mul_f32 v[64:65], v[64:65], v[28:29] op_sel_hi:[1,0]
    v_pk_mul_f32 v[66:67], v[66:67], v[28:29] op_sel_hi:[1,0]
    v_pk_mul_f32 v[68:69], v[68:69], v[28:29] op_sel_hi:[1,0]
    v_pk_mul_f32 v[70:71], v[70:71], v[28:29] op_sel_hi:[1,0]
    v_cvt_pk_bf16_f32 v76, v64, v65
    v_cvt_pk_bf16_f32 v77, v66, v67
    v_cvt_pk_bf16_f32 v78, v68, v69
    v_cvt_pk_bf16_f32 v79, v70, v71
    ds_write_b64 v22, v[76:77] offset:64
    ds_write_b64 v22, v[78:79] offset:72
    ds_read_b128 v[72:75], v23
    ds_read_b128 v[76:79], v23 offset:1152
    v_accvgpr_read_b32 v80, a52
    v_accvgpr_read_b32 v81, a53
    v_accvgpr_read_b32 v82, a54
    v_accvgpr_read_b32 v83, a55
    v_accvgpr_read_b32 v84, a64
    v_accvgpr_read_b32 v85, a65
    v_accvgpr_read_b32 v86, a66
    v_accvgpr_read_b32 v87, a67
    v_pk_mul_f32 v[80:81], v[80:81], v[28:29] op_sel:[0,1] op_sel_hi:[1,1]
    v_pk_mul_f32 v[82:83], v[82:83], v[28:29] op_sel:[0,1] op_sel_hi:[1,1]
    v_pk_mul_f32 v[84:85], v[84:85], v[28:29] op_sel:[0,1] op_sel_hi:[1,1]
    v_pk_mul_f32 v[86:87], v[86:87], v[28:29] op_sel:[0,1] op_sel_hi:[1,1]
    v_cvt_pk_bf16_f32 v88, v80, v81
    v_cvt_pk_bf16_f32 v89, v82, v83
    v_cvt_pk_bf16_f32 v90, v84, v85
    v_cvt_pk_bf16_f32 v91, v86, v87
    ds_write_b64 v22, v[88:89] offset:0
    ds_write_b64 v22, v[90:91] offset:8
    v_accvgpr_read_b32 v80, a76
    v_accvgpr_read_b32 v81, a77
    v_accvgpr_read_b32 v82, a78
    v_accvgpr_read_b32 v83, a79
    v_accvgpr_read_b32 v84, a88
    v_accvgpr_read_b32 v85, a89
    v_accvgpr_read_b32 v86, a90
    v_accvgpr_read_b32 v87, a91
    v_pk_mul_f32 v[80:81], v[80:81], v[28:29] op_sel:[0,1] op_sel_hi:[1,1]
    v_pk_mul_f32 v[82:83], v[82:83], v[28:29] op_sel:[0,1] op_sel_hi:[1,1]
    v_pk_mul_f32 v[84:85], v[84:85], v[28:29] op_sel:[0,1] op_sel_hi:[1,1]
    v_pk_mul_f32 v[86:87], v[86:87], v[28:29] op_sel:[0,1] op_sel_hi:[1,1]
    v_cvt_pk_bf16_f32 v92, v80, v81
    v_cvt_pk_bf16_f32 v93, v82, v83
    v_cvt_pk_bf16_f32 v94, v84, v85
    v_cvt_pk_bf16_f32 v95, v86, v87
    s_waitcnt lgkmcnt(2)
    buffer_store_dwordx4 v[72:75], v0, s[20:23], s54 offen offset:384 nt
    buffer_store_dwordx4 v[76:79], v0, s[20:23], s55 offen offset:384 nt
    ds_write_b64 v22, v[92:93] offset:64
    ds_write_b64 v22, v[94:95] offset:72
    ds_read_b128 v[88:91], v23
    ds_read_b128 v[92:95], v23 offset:1152
    v_accvgpr_read_b32 v96, a56
    v_accvgpr_read_b32 v97, a57
    v_accvgpr_read_b32 v98, a58
    v_accvgpr_read_b32 v99, a59
    v_accvgpr_read_b32 v100, a68
    v_accvgpr_read_b32 v101, a69
    v_accvgpr_read_b32 v102, a70
    v_accvgpr_read_b32 v103, a71
    v_pk_mul_f32 v[96:97], v[96:97], v[30:31] op_sel_hi:[1,0]
    v_pk_mul_f32 v[98:99], v[98:99], v[30:31] op_sel_hi:[1,0]
    v_pk_mul_f32 v[100:101], v[100:101], v[30:31] op_sel_hi:[1,0]
    v_pk_mul_f32 v[102:103], v[102:103], v[30:31] op_sel_hi:[1,0]
    v_cvt_pk_bf16_f32 v104, v96, v97
    v_cvt_pk_bf16_f32 v105, v98, v99
    v_cvt_pk_bf16_f32 v106, v100, v101
    v_cvt_pk_bf16_f32 v107, v102, v103
    ds_write_b64 v22, v[104:105] offset:0
    ds_write_b64 v22, v[106:107] offset:8
    v_accvgpr_read_b32 v96, a80
    v_accvgpr_read_b32 v97, a81
    v_accvgpr_read_b32 v98, a82
    v_accvgpr_read_b32 v99, a83
    v_accvgpr_read_b32 v100, a92
    v_accvgpr_read_b32 v101, a93
    v_accvgpr_read_b32 v102, a94
    v_accvgpr_read_b32 v103, a95
    v_pk_mul_f32 v[96:97], v[96:97], v[30:31] op_sel_hi:[1,0]
    v_pk_mul_f32 v[98:99], v[98:99], v[30:31] op_sel_hi:[1,0]
    v_pk_mul_f32 v[100:101], v[100:101], v[30:31] op_sel_hi:[1,0]
    v_pk_mul_f32 v[102:103], v[102:103], v[30:31] op_sel_hi:[1,0]
    v_cvt_pk_bf16_f32 v108, v96, v97
    v_cvt_pk_bf16_f32 v109, v98, v99
    v_cvt_pk_bf16_f32 v110, v100, v101
    v_cvt_pk_bf16_f32 v111, v102, v103
    s_waitcnt lgkmcnt(2)
    buffer_store_dwordx4 v[88:91], v0, s[20:23], s56 offen offset:384 nt
    buffer_store_dwordx4 v[92:95], v0, s[20:23], s57 offen offset:384 nt
    ds_write_b64 v22, v[108:109] offset:64
    ds_write_b64 v22, v[110:111] offset:72
    ds_read_b128 v[104:107], v23
    ds_read_b128 v[108:111], v23 offset:1152
    s_waitcnt lgkmcnt(0)
    buffer_store_dwordx4 v[104:107], v0, s[20:23], s58 offen offset:384 nt
    buffer_store_dwordx4 v[108:111], v0, s[20:23], s59 offen offset:384 nt
L_end:
    s_endpgm
L_fallback:
    s_waitcnt vmcnt(0) lgkmcnt(0)
    s_barrier
    v_mov_b32 v19, 0xff800000
    v_mov_b32 v20, 0xff800000
    v_mov_b32 v21, 0xff800000
    s_mov_b32 s53, 0
L_fb_loop:
    s_mov_b32 m0, s28
    s_lshl_b32 s30, s53, 14
    buffer_load_dwordx4 v5, s[12:15], s30 offen offset:0 lds
    buffer_load_dwordx4 v6, s[12:15], s30 offen offset:1056 lds
    buffer_load_dwordx4 v7, s[12:15], s30 offen offset:2112 lds
    buffer_load_dwordx4 v8, s[12:15], s30 offen offset:3168 lds
    s_waitcnt vmcnt(0)
    s_barrier
    ds_read_b128 a[144:147], v2 offset:0
    ds_read_b128 a[148:151], v2 offset:64
    ds_read_b128 a[152:155], v2 offset:128
    ds_read_b128 a[156:159], v2 offset:192
    ds_read_b128 a[160:163], v2 offset:256
    ds_read_b128 a[164:167], v2 offset:320
    ds_read_b128 a[168:171], v2 offset:384
    ds_read_b128 a[172:175], v2 offset:448
    s_waitcnt lgkmcnt(0)
    v_mfma_f32_16x16x32_bf16 v[40:43], a[144:147], a[0:3], 0
    v_mfma_f32_16x16x32_bf16 v[44:47], a[144:147], a[32:35], 0
    v_mfma_f32_16x16x32_bf16 v[48:51], a[144:147], a[64:67], 0
    v_mfma_f32_16x16x32_bf16 v[40:43], a[148:151], a[4:7], v[40:43]
    v_mfma_f32_16x16x32_bf16 v[44:47], a[148:151], a[36:39], v[44:47]
    v_mfma_f32_16x16x32_bf16 v[48:51], a[148:151], a[68:71], v[48:51]
    v_mfma_f32_16x16x32_bf16 v[40:43], a[152:155], a[8:11], v[40:43]
    v_mfma_f32_16x16x32_bf16 v[44:47], a[152:155], a[40:43], v[44:47]
    v_mfma_f32_16x16x32_bf16 v[48:51], a[152:155], a[72:75], v[48:51]
    v_mfma_f32_16x16x32_bf16 v[40:43], a[156:159], a[12:15], v[40:43]
    v_mfma_f32_16x16x32_bf16 v[44:47], a[156:159], a[44:47], v[44:47]
    v_mfma_f32_16x16x32_bf16 v[48:51], a[156:159], a[76:79], v[48:51]
    v_mfma_f32_16x16x32_bf16 v[40:43], a[160:163], a[16:19], v[40:43]
    v_mfma_f32_16x16x32_bf16 v[44:47], a[160:163], a[48:51], v[44:47]
    v_mfma_f32_16x16x32_bf16 v[48:51], a[160:163], a[80:83], v[48:51]
    v_mfma_f32_16x16x32_bf16 v[40:43], a[164:167], a[20:23], v[40:43]
    v_mfma_f32_16x16x32_bf16 v[44:47], a[164:167], a[52:55], v[44:47]
    v_mfma_f32_16x16x32_bf16 v[48:51], a[164:167], a[84:87], v[48:51]
    v_mfma_f32_16x16x32_bf16 v[40:43], a[168:171], a[24:27], v[40:43]
    v_mfma_f32_16x16x32_bf16 v[44:47], a[168:171], a[56:59], v[44:47]
    v_mfma_f32_16x16x32_bf16 v[48:51], a[168:171], a[88:91], v[48:51]
    v_mfma_f32_16x16x32_bf16 v[40:43], a[172:175], a[28:31], v[40:43]
    v_mfma_f32_16x16x32_bf16 v[44:47], a[172:175], a[60:63], v[44:47]
    v_mfma_f32_16x16x32_bf16 v[48:51], a[172:175], a[92:95], v[48:51]
    s_nop 7
    s_nop 7
    v_max3_f32 v19, v19, v40, v41
    v_max3_f32 v19, v19, v42, v43
    v_max3_f32 v20, v20, v44, v45
    v_max3_f32 v20, v20, v46, v47
    v_max3_f32 v21, v21, v48, v49
    v_max3_f32 v21, v21, v50, v51
    s_nop 3
    ds_read_b128 a[144:147], v2 offset:8448
    ds_read_b128 a[148:151], v2 offset:8512
    ds_read_b128 a[152:155], v2 offset:8576
    ds_read_b128 a[156:159], v2 offset:8640
    ds_read_b128 a[160:163], v2 offset:8704
    ds_read_b128 a[164:167], v2 offset:8768
    ds_read_b128 a[168:171], v2 offset:8832
    ds_read_b128 a[172:175], v2 offset:8896
    s_waitcnt lgkmcnt(0)
    v_mfma_f32_16x16x32_bf16 v[40:43], a[144:147], a[0:3], 0
    v_mfma_f32_16x16x32_bf16 v[44:47], a[144:147], a[32:35], 0
    v_mfma_f32_16x16x32_bf16 v[48:51], a[144:147], a[64:67], 0
    v_mfma_f32_16x16x32_bf16 v[40:43], a[148:151], a[4:7], v[40:43]
    v_mfma_f32_16x16x32_bf16 v[44:47], a[148:151], a[36:39], v[44:47]
    v_mfma_f32_16x16x32_bf16 v[48:51], a[148:151], a[68:71], v[48:51]
    v_mfma_f32_16x16x32_bf16 v[40:43], a[152:155], a[8:11], v[40:43]
    v_mfma_f32_16x16x32_bf16 v[44:47], a[152:155], a[40:43], v[44:47]
    v_mfma_f32_16x16x32_bf16 v[48:51], a[152:155], a[72:75], v[48:51]
    v_mfma_f32_16x16x32_bf16 v[40:43], a[156:159], a[12:15], v[40:43]
    v_mfma_f32_16x16x32_bf16 v[44:47], a[156:159], a[44:47], v[44:47]
    v_mfma_f32_16x16x32_bf16 v[48:51], a[156:159], a[76:79], v[48:51]
    v_mfma_f32_16x16x32_bf16 v[40:43], a[160:163], a[16:19], v[40:43]
    v_mfma_f32_16x16x32_bf16 v[44:47], a[160:163], a[48:51], v[44:47]
    v_mfma_f32_16x16x32_bf16 v[48:51], a[160:163], a[80:83], v[48:51]
    v_mfma_f32_16x16x32_bf16 v[40:43], a[164:167], a[20:23], v[40:43]
    v_mfma_f32_16x16x32_bf16 v[44:47], a[164:167], a[52:55], v[44:47]
    v_mfma_f32_16x16x32_bf16 v[48:51], a[164:167], a[84:87], v[48:51]
    v_mfma_f32_16x16x32_bf16 v[40:43], a[168:171], a[24:27], v[40:43]
    v_mfma_f32_16x16x32_bf16 v[44:47], a[168:171], a[56:59], v[44:47]
    v_mfma_f32_16x16x32_bf16 v[48:51], a[168:171], a[88:91], v[48:51]
    v_mfma_f32_16x16x32_bf16 v[40:43], a[172:175], a[28:31], v[40:43]
    v_mfma_f32_16x16x32_bf16 v[44:47], a[172:175], a[60:63], v[44:47]
    v_mfma_f32_16x16x32_bf16 v[48:51], a[172:175], a[92:95], v[48:51]
    s_nop 7
    s_nop 7
    v_max3_f32 v19, v19, v40, v41
    v_max3_f32 v19, v19, v42, v43
    v_max3_f32 v20, v20, v44, v45
    v_max3_f32 v20, v20, v46, v47
    v_max3_f32 v21, v21, v48, v49
    v_max3_f32 v21, v21, v50, v51
    s_nop 3
    s_barrier
    s_add_u32 s53, s53, 1
    s_cmp_lt_u32 s53, 16
    s_cbranch_scc1 L_fb_loop
    v_mov_b32 v24, v19
    v_mov_b32 v25, v24
    s_nop 1
    v_permlane32_swap_b32 v24, v25
    s_nop 1
    v_max_f32 v24, v24, v25
    v_mov_b32 v25, v24
    s_nop 1
    v_permlane16_swap_b32 v24, v25
    s_nop 1
    v_max_f32 v24, v24, v25
    v_sub_f32 v28, 0, v24
    v_sub_f32 v29, 0, v24
    v_sub_f32 v30, 0, v24
    v_sub_f32 v31, 0, v24
    v_mov_b32 v24, v20
    v_mov_b32 v25, v24
    s_nop 1
    v_permlane32_swap_b32 v24, v25
    s_nop 1
    v_max_f32 v24, v24, v25
    v_mov_b32 v25, v24
    s_nop 1
    v_permlane16_swap_b32 v24, v25
    s_nop 1
    v_max_f32 v24, v24, v25
    v_sub_f32 v32, 0, v24
    v_sub_f32 v33, 0, v24
    v_sub_f32 v34, 0, v24
    v_sub_f32 v35, 0, v24
    v_mov_b32 v24, v21
    v_mov_b32 v25, v24
    s_nop 1
    v_permlane32_swap_b32 v24, v25
    s_nop 1
    v_max_f32 v24, v24, v25
    v_mov_b32 v25, v24
    s_nop 1
    v_permlane16_swap_b32 v24, v25
    s_nop 1
    v_max_f32 v24, v24, v25
    v_sub_f32 v36, 0, v24
    v_sub_f32 v37, 0, v24
    v_sub_f32 v38, 0, v24
    v_sub_f32 v39, 0, v24
    s_add_u32 m0, s28, 0
    s_mov_b32 s30, 0
    buffer_load_dwordx4 v5, s[12:15], s30 offen offset:0 nt lds
    buffer_load_dwordx4 v6, s[12:15], s30 offen offset:1056 nt lds
    buffer_load_dwordx4 v7, s[12:15], s30 offen offset:2112 nt lds
    buffer_load_dwordx4 v8, s[12:15], s30 offen offset:3168 nt lds
    s_add_u32 m0, s28, 16896
    s_mov_b32 s30, 16384
    buffer_load_dwordx4 v5, s[12:15], s30 offen offset:0 nt lds
    buffer_load_dwordx4 v6, s[12:15], s30 offen offset:1056 nt lds
    buffer_load_dwordx4 v7, s[12:15], s30 offen offset:2112 nt lds
    buffer_load_dwordx4 v8, s[12:15], s30 offen offset:3168 nt lds
    s_add_u32 m0, s28, 33792
    s_mov_b32 s30, 32768
    buffer_load_dwordx4 v5, s[12:15], s30 offen offset:0 nt lds
    buffer_load_dwordx4 v6, s[12:15], s30 offen offset:1056 nt lds
    buffer_load_dwordx4 v7, s[12:15], s30 offen offset:2112 nt lds
    buffer_load_dwordx4 v8, s[12:15], s30 offen offset:3168 nt lds
    s_waitcnt vmcnt(0)
    s_barrier
    ds_read_b128 a[144:147], v2 offset:0
    ds_read_b128 a[148:151], v2 offset:64
    ds_read_b128 a[152:155], v2 offset:128
    ds_read_b128 a[156:159], v2 offset:192
    ds_read_b128 a[160:163], v2 offset:256
    ds_read_b128 a[164:167], v2 offset:320
    ds_read_b128 a[168:171], v2 offset:384
    ds_read_b128 a[172:175], v2 offset:448
    s_waitcnt lgkmcnt(0)
    ds_read_b128 a[176:179], v2 offset:8448
    ds_read_b128 a[180:183], v2 offset:8512
    ds_read_b128 a[184:187], v2 offset:8576
    ds_read_b128 a[188:191], v2 offset:8640
    ds_read_b128 a[192:195], v2 offset:8704
    ds_read_b128 a[196:199], v2 offset:8768
    s_waitcnt lgkmcnt(0)
    v_mfma_f32_16x16x32_bf16 v[40:43], a[144:147], a[0:3], 0
    v_mfma_f32_16x16x32_bf16 v[44:47], a[144:147], a[32:35], 0
    v_mfma_f32_16x16x32_bf16 v[48:51], a[144:147], a[64:67], 0
    v_mfma_f32_16x16x32_bf16 v[40:43], a[148:151], a[4:7], v[40:43]
    v_mfma_f32_16x16x32_bf16 v[44:47], a[148:151], a[36:39], v[44:47]
    v_mfma_f32_16x16x32_bf16 v[48:51], a[148:151], a[68:71], v[48:51]
    v_mfma_f32_16x16x32_bf16 v[40:43], a[152:155], a[8:11], v[40:43]
    v_mfma_f32_16x16x32_bf16 v[44:47], a[152:155], a[40:43], v[44:47]
    v_mfma_f32_16x16x32_bf16 v[48:51], a[152:155], a[72:75], v[48:51]
    v_mfma_f32_16x16x32_bf16 v[40:43], a[156:159], a[12:15], v[40:43]
    v_mfma_f32_16x16x32_bf16 v[44:47], a[156:159], a[44:47], v[44:47]
    v_mfma_f32_16x16x32_bf16 v[48:51], a[156:159], a[76:79], v[48:51]
    v_mfma_f32_16x16x32_bf16 v[40:43], a[160:163], a[16:19], v[40:43]
    v_mfma_f32_16x16x32_bf16 v[44:47], a[160:163], a[48:51], v[44:47]
    v_mfma_f32_16x16x32_bf16 v[48:51], a[160:163], a[80:83], v[48:51]
    v_mfma_f32_16x16x32_bf16 v[40:43], a[164:167], a[20:23], v[40:43]
    v_mfma_f32_16x16x32_bf16 v[44:47], a[164:167], a[52:55], v[44:47]
    v_mfma_f32_16x16x32_bf16 v[48:51], a[164:167], a[84:87], v[48:51]
    v_mfma_f32_16x16x32_bf16 v[40:43], a[168:171], a[24:27], v[40:43]
    v_mfma_f32_16x16x32_bf16 v[44:47], a[168:171], a[56:59], v[44:47]
    v_mfma_f32_16x16x32_bf16 v[48:51], a[168:171], a[88:91], v[48:51]
    v_mfma_f32_16x16x32_bf16 v[40:43], a[172:175], a[28:31], v[40:43]
    v_mfma_f32_16x16x32_bf16 v[44:47], a[172:175], a[60:63], v[44:47]
    v_mfma_f32_16x16x32_bf16 v[48:51], a[172:175], a[92:95], v[48:51]
    s_nop 7
    s_nop 7
    v_add_f32 v40, v28, v40
    v_add_f32 v41, v29, v41
    v_add_f32 v42, v30, v42
    v_add_f32 v43, v31, v43
    v_add_f32 v44, v32, v44
    v_add_f32 v45, v33, v45
    v_add_f32 v46, v34, v46
    v_add_f32 v47, v35, v47
    v_add_f32 v48, v36, v48
    v_add_f32 v49, v37, v49
    v_add_f32 v50, v38, v50
    v_add_f32 v51, v39, v51
    s_mov_b32 s36, 1
    s_branch L_join
L_code_end:
    s_endpgm
.section .rodata,"a"
.p2align 6
.amdhsa_kernel standalone__gqa_softmax__near_ridge_kernel
  .amdhsa_next_free_vgpr 512
  .amdhsa_next_free_sgpr 96
  .amdhsa_accum_offset 256
  .amdhsa_group_segment_fixed_size 0
  .amdhsa_kernarg_size 48
  .amdhsa_user_sgpr_count 2
  .amdhsa_user_sgpr_kernarg_segment_ptr 1
  .amdhsa_system_sgpr_workgroup_id_x 1
  .amdhsa_float_denorm_mode_32 3
.end_amdhsa_kernel
```
